```python
import torch

def _softmax(x, axis=-1):
    return torch.softmax(x, dim=axis)
def _gelu(x):
    return torch.nn.functional.gelu(x, approximate="tanh")
def _silu(x):
    return torch.nn.functional.silu(x)
def _sigmoid(x):
    return torch.sigmoid(x)
def _layernorm(x, axis=-1, eps=1e-5):
    m = x.mean(dim=axis, keepdim=True)
    v = x.var(dim=axis, keepdim=True, unbiased=False)
    return (x - m) / torch.sqrt(v + eps)
def _scatter_add(tgt, idx, src, axis=0):
    return tgt.clone().index_add_(axis, idx, src)
def _segment_sum(src, seg, n):
    out = torch.zeros((n,) + src.shape[1:], dtype=src.dtype)
    return out.index_add_(0, seg, src)
def _pad(x, pw):
    flat = tuple(v for pair in reversed(pw) for v in pair)
    return torch.nn.functional.pad(x, flat)

kernel_name = 'standalone__weight_only_int_squeezellm__prompt'

def setup_inputs():

    _w = (lambda a: (lambda t: t.to(torch.bfloat16) if t.is_floating_point() else t)(torch.as_tensor(a)))
    B, S, D, F = 1, 2048, 576, 4608
    bits = 3 if (2 <= 3 <= 4) else 4
    L = 2 ** bits
    qw = torch.randint(0, L, (D, F)).to(torch.int64)
    lut = (lambda *s: torch.randn(*s, dtype=torch.bfloat16) * 0.05)(L, F)
    return {
        "x": _w((lambda *s: torch.randn(*s, dtype=torch.bfloat16) * 0.05)(B, S, D)),
        "qw": _w(qw),
        "lut": _w(lut),
    }

def reference(x, qw, lut):
    w = (lambda x, i, axis: torch.take_along_dim(x, i, dim=axis))(lut, qw, axis=0)
    w = (lambda x, dt: x.to(dt))(w, x.dtype)
    return torch.einsum('bsd,df->bsf', x, w)
```

```asm
; @launch grid=(256,1,1) block=(256,1,1) lds=161792
.amdgcn_target "amdgcn-amd-amdhsa--gfx950"
.text
.globl standalone__weight_only_int_squeezellm__prompt_kernel
.p2align 8
.type standalone__weight_only_int_squeezellm__prompt_kernel,@function
standalone__weight_only_int_squeezellm__prompt_kernel:
s_load_dwordx2 s[16:17], s[0:1], 8
s_load_dwordx2 s[12:13], s[0:1], 0
s_load_dwordx2 s[20:21], s[0:1], 16
s_load_dwordx2 s[24:25], s[0:1], 24
s_and_b32 s4, s2, 7
s_lshr_b32 s5, s2, 3
s_bfe_u32 s6, s2, 0x10000
s_lshl_b32 s6, s6, 5
s_add_u32 s6, s6, s5
s_cmp_ge_u32 s2, 256
s_cselect_b32 s7, 63, s6
s_cmp_ge_u32 s7, 63
s_cbranch_scc1 L_end
v_lshrrev_b32 v40, 6, v0
s_mul_i32 s7, s6, 9363
v_readfirstlane_b32 s62, v40
v_and_b32 v104, 63, v0
s_lshr_b32 s7, s7, 16
s_mul_i32 s8, s7, 7
s_sub_u32 s65, s6, s8
s_cmp_lg_u32 s62, 3
s_cbranch_scc1 L_nopf
s_getpc_b64 s[46:47]
L_pc:
s_lshr_b32 s8, s2, 3
s_mul_i32 s9, s8, 4097
s_lshr_b32 s9, s9, 16
s_mul_i32 s9, s9, 16
s_sub_u32 s8, s8, s9
s_lshl_b32 s8, s8, 10
s_add_u32 s8, s8, L_main-L_pc
v_lshl_add_u32 v42, v104, 4, s8
global_load_dwordx4 v[252:255], v42, s[46:47]
L_nopf:
s_lshr_b32 s8, s4, 1
s_mul_i32 s8, s8, 9
s_add_u32 s64, s7, s8
s_add_u32 s8, s65, s64
s_mul_i32 s9, s64, 21846
s_lshr_b32 s9, s9, 16
s_mul_i32 s9, s9, 3
s_sub_u32 s6, s64, s9
s_mul_i32 s9, s8, 13108
s_lshr_b32 s9, s9, 16
s_mul_i32 s9, s9, 5
s_sub_u32 s8, s8, s9
s_mov_b32 s10, 0x10210
s_cmp_lt_u32 s65, 2
s_cselect_b32 s8, s6, s8
s_cselect_b32 s10, 0x102, s10
s_cselect_b32 s1, 5, 0
s_add_u32 s1, s1, s8
s_lshl_b32 s8, s8, 2
s_lshr_b32 s10, s10, s8
s_bfe_u32 s37, s10, 0x40000
s_lshl_b32 s28, s37, 7
s_mul_i32 s37, s37, 1179648
v_lshrrev_b32 v105, 4, v104
v_and_b32 v106, 15, v104
s_lshr_b32 s61, s62, 1
s_and_b32 s4, s62, 1
s_lshl1_add_u32 s5, s64, s4
s_lshl_b32 s6, s5, 8
s_mul_i32 s7, s61, 589824
s_add_u32 s6, s6, s7
v_mul_u32_u24 v40, 147456, v105
v_lshl_add_u32 v40, v106, 4, v40
v_add_u32 v0, s6, v40
v_add_u32 v1, 18432, v0
v_add_u32 v2, 36864, v0
v_add_u32 v3, 55296, v0
v_add_u32 v4, 73728, v0
v_add_u32 v5, 92160, v0
v_add_u32 v6, 110592, v0
v_add_u32 v7, 129024, v0
s_mov_b32 s18, 10616832
s_mov_b32 s19, 0x00020000
v_lshrrev_b32 v107, 3, v104
v_and_b32 v108, 7, v104
v_mul_u32_u24 v40, 9216, v107
v_lshl_add_u32 v40, v108, 4, v40
s_lshl_b32 s5, s5, 7
s_mov_b32 s22, 73728
s_mov_b32 s23, 0x00020000
s_lshl_b32 s55, s62, 12
s_add_u32 m0, s55, 145408
s_waitcnt lgkmcnt(0)
buffer_load_dwordx4 v40, s[20:23], s5 offen lds
tbuffer_load_format_d16_xyzw v[112:113], v0, s[16:19], s37 format:[BUF_DATA_FORMAT_32_32_32_32,BUF_NUM_FORMAT_UINT] offen
tbuffer_load_format_d16_xyzw v[114:115], v1, s[16:19], s37 format:[BUF_DATA_FORMAT_32_32_32_32,BUF_NUM_FORMAT_UINT] offen
tbuffer_load_format_d16_xyzw v[116:117], v2, s[16:19], s37 format:[BUF_DATA_FORMAT_32_32_32_32,BUF_NUM_FORMAT_UINT] offen
tbuffer_load_format_d16_xyzw v[118:119], v3, s[16:19], s37 format:[BUF_DATA_FORMAT_32_32_32_32,BUF_NUM_FORMAT_UINT] offen
tbuffer_load_format_d16_xyzw v[120:121], v4, s[16:19], s37 format:[BUF_DATA_FORMAT_32_32_32_32,BUF_NUM_FORMAT_UINT] offen
tbuffer_load_format_d16_xyzw v[122:123], v5, s[16:19], s37 format:[BUF_DATA_FORMAT_32_32_32_32,BUF_NUM_FORMAT_UINT] offen
tbuffer_load_format_d16_xyzw v[124:125], v6, s[16:19], s37 format:[BUF_DATA_FORMAT_32_32_32_32,BUF_NUM_FORMAT_UINT] offen
tbuffer_load_format_d16_xyzw v[126:127], v7, s[16:19], s37 format:[BUF_DATA_FORMAT_32_32_32_32,BUF_NUM_FORMAT_UINT] offen
s_min_u32 s9, s65, 2
s_mul_i32 s6, s65, 18
s_add_u32 s63, s6, s9
v_xor_b32 v40, v105, v108
v_mul_u32_u24 v41, 1152, v107
v_lshl_add_u32 v109, v40, 4, v41
s_lshl1_add_u32 s8, s62, s63
s_mul_i32 s8, s8, 18432
v_add_u32 v8, s8, v109
v_xor_b32 v40, 64, v109
s_add_u32 s8, s8, 8192
v_add_u32 v9, s8, v40
v_add_u32 v10, 16384, v8
v_add_u32 v11, 16384, v9
s_mov_b32 s14, 2359296
s_mov_b32 s15, 0x00020000
s_lshl_b32 s7, s4, 6
v_xor_b32 v109, s7, v109
s_add_u32 s8, s63, s61
s_mul_i32 s8, s8, 18432
s_mul_i32 s7, s4, 9216
s_add_u32 s8, s8, s7
s_add_u32 s8, s8, 145408
v_add_u32 v13, s8, v109
s_add_u32 m0, s55, 73728
s_nop 0
buffer_load_dwordx4 v8, s[12:15], s28 offen  lds
buffer_load_dwordx4 v9, s[12:15], s28 offen offset:1024  lds
buffer_load_dwordx4 v10, s[12:15], s28 offen offset:2048  lds
buffer_load_dwordx4 v11, s[12:15], s28 offen offset:3072  lds
s_sub_u32 s22, s62, 0
s_cmp_ge_u32 s22, 2
s_cbranch_scc1 L_notouch
s_lshl1_add_u32 s22, s64, s22
v_min_u32 v111, 37, v104
s_mul_i32 s22, s22, 4864
s_mul_i32 s23, s63, 18432
s_add_u32 s22, s22, s23
v_lshlrev_b32 v111, 7, v111
buffer_load_dword v96, v111, s[12:15], s22 offen
L_notouch:
s_cmp_lg_u32 s62, 0
s_cbranch_scc1 L_nohop_0
s_mov_b64 exec, 0
s_branch L_page_0
L_nohop_0:
s_cmp_lg_u32 s62, 1
s_cbranch_scc1 L_nohop_1
s_mov_b64 exec, 0
s_branch L_page_1
L_nohop_1:
s_cmp_lg_u32 s62, 2
s_cbranch_scc1 L_nohop_2
s_mov_b64 exec, 0
s_branch L_page_2
L_nohop_2:
s_mov_b64 exec, 0
s_branch L_page_3
L_hopback:
s_mov_b64 exec, -1
s_mov_b32 s10, 0x76542130
s_mov_b32 s11, 8
s_cmp_eq_u32 s1, 1
s_cselect_b32 s10, 0x76530421, s10
s_cselect_b32 s11, 8, s11
s_cmp_eq_u32 s1, 2
s_cselect_b32 s10, 0x76435102, s10
s_cselect_b32 s11, 8, s11
s_cmp_eq_u32 s1, 3
s_cselect_b32 s10, 0x75463210, s10
s_cselect_b32 s11, 8, s11
s_cmp_eq_u32 s1, 4
s_cselect_b32 s10, 0x65743021, s10
s_cselect_b32 s11, 8, s11
s_cmp_eq_u32 s1, 5
s_cselect_b32 s10, 0x76543012, s10
s_cselect_b32 s11, 8, s11
s_cmp_eq_u32 s1, 6
s_cselect_b32 s10, 0x76543210, s10
s_cselect_b32 s11, 8, s11
s_cmp_eq_u32 s1, 7
s_cselect_b32 s10, 0x76543021, s10
s_cselect_b32 s11, 8, s11
s_bfe_u32 s38, s10, 0x40004
s_lshl_b32 s29, s38, 7
s_mul_i32 s38, s38, 1179648
s_bfe_u32 s39, s10, 0x40008
s_lshl_b32 s30, s39, 7
s_mul_i32 s39, s39, 1179648
s_bfe_u32 s40, s10, 0x4000c
s_lshl_b32 s31, s40, 7
s_mul_i32 s40, s40, 1179648
s_bfe_u32 s41, s10, 0x40010
s_lshl_b32 s32, s41, 7
s_mul_i32 s41, s41, 1179648
s_bfe_u32 s42, s10, 0x40014
s_lshl_b32 s33, s42, 7
s_mul_i32 s42, s42, 1179648
s_bfe_u32 s43, s10, 0x40018
s_lshl_b32 s34, s43, 7
s_mul_i32 s43, s43, 1179648
s_bfe_u32 s44, s10, 0x4001c
s_lshl_b32 s35, s44, 7
s_mul_i32 s44, s44, 1179648
s_bfe_u32 s45, s11, 0x40000
s_lshl_b32 s36, s45, 7
s_mul_i32 s45, s45, 1179648
s_add_u32 s46, s28, 2048
s_add_u32 s47, s29, 0
s_add_u32 s48, s30, 2048
s_add_u32 s49, s31, 0
s_add_u32 s50, s32, 2048
s_add_u32 s51, s33, 0
s_add_u32 s52, s34, 2048
s_add_u32 s53, s35, 0
s_add_u32 s54, s36, 2048
tbuffer_load_format_d16_xyzw v[128:129], v0, s[16:19], s38 format:[BUF_DATA_FORMAT_32_32_32_32,BUF_NUM_FORMAT_UINT] offen
tbuffer_load_format_d16_xyzw v[130:131], v1, s[16:19], s38 format:[BUF_DATA_FORMAT_32_32_32_32,BUF_NUM_FORMAT_UINT] offen
s_sub_u32 s1, s1, 1
s_cmp_eq_u32 s62, 1
s_cselect_b32 s1, s1, 99
s_mov_b32 s7, s1
v_lshrrev_b32 v110, 2, v104
s_and_b32 s7, s7, 3
s_lshl_b32 s7, s7, 4
s_add_u32 s7, s7, 512
v_add_u32 v110, s7, v110
v_mul_u32_u24 v110, 18432, v110
v_and_b32 v40, 3, v104
v_lshl_add_u32 v110, v40, 7, v110
s_lshl_b32 s7, s64, 9
v_add_u32 v110, s7, v110
s_lshl_b32 s7, s61, 2
v_add_u32 v40, s7, v105
v_lshrrev_b32 v41, 1, v106
v_xor_b32 v40, v40, v41
v_lshlrev_b32 v40, 4, v40
v_lshl_add_u32 v40, v106, 7, v40
s_mul_i32 s7, s61, 8192
s_add_u32 s7, s7, 73728
v_add_u32 v14, s7, v40
v_xor_b32 v15, 64, v14
s_mul_i32 s7, s61, 18432
v_add_u32 v16, s7, v40
v_xor_b32 v17, 64, v16
s_add_u32 s7, s55, 129024
v_lshl_add_u32 v18, v104, 4, s7
s_xor_b32 s7, s55, 8192
s_add_u32 s7, s7, 129024
v_lshl_add_u32 v19, v104, 4, s7
s_add_u32 s7, s55, 145408
v_lshl_add_u32 v111, v106, 3, s7
tbuffer_load_format_d16_xyzw v[132:133], v2, s[16:19], s38 format:[BUF_DATA_FORMAT_32_32_32_32,BUF_NUM_FORMAT_UINT] offen
tbuffer_load_format_d16_xyzw v[134:135], v3, s[16:19], s38 format:[BUF_DATA_FORMAT_32_32_32_32,BUF_NUM_FORMAT_UINT] offen
s_lshl1_add_u32 s5, s64, s4
s_lshl_b32 s5, s5, 7
s_mul_i32 s8, s63, 147456
s_add_u32 s8, s8, s5
v_mul_u32_u24 v40, 36864, v105
v_lshl_add_u32 v40, v106, 3, v40
v_add_u32 v20, s8, v40
v_add_u32 v21, 9216, v20
v_add_u32 v22, 18432, v20
v_add_u32 v23, 27648, v20
s_mul_i32 s21, s61, 589824
s_cmp_lt_u32 s65, 2
s_cselect_b32 s20, 1, 0
s_mov_b32 s26, 18874368
s_mov_b32 s27, 0x00020000
s_mul_i32 s56, s61, 18432
s_lshl_b32 s7, s4, 10
s_add_u32 s56, s56, s7
s_add_u32 s3, s61, 8
s_mul_i32 s3, s3, 147456
s_mul_i32 s9, s64, 13108
s_lshr_b32 s9, s9, 16
s_mul_i32 s9, s9, 5
s_sub_u32 s23, s64, s9
s_mul_i32 s0, s23, 36864
v_add_u32 v13, s0, v13
s_mov_b32 s0, 36864
s_mul_i32 s96, s23, 294912
s_add_u32 s96, s96, s3
s_add_u32 s23, s23, 1
s_cmp_eq_u32 s23, 5
s_cselect_b32 s23, 0, s23
s_cselect_b32 s5, 0xfffdc000, s0
s_mul_i32 s97, s23, 294912
s_add_u32 s97, s97, s3
s_add_u32 s23, s23, 1
s_cmp_eq_u32 s23, 5
s_cselect_b32 s23, 0, s23
s_cselect_b32 s6, 0xfffdc000, s0
s_mul_i32 s98, s23, 294912
s_add_u32 s98, s98, s3
s_add_u32 s23, s23, 1
s_cmp_eq_u32 s23, 5
s_cselect_b32 s23, 0, s23
s_cselect_b32 s7, 0xfffdc000, s0
s_mul_i32 s99, s23, 294912
s_add_u32 s99, s99, s3
s_add_u32 s23, s23, 1
s_cmp_eq_u32 s23, 5
s_cselect_b32 s23, 0, s23
s_cselect_b32 s8, 0xfffdc000, s0
s_mul_i32 s100, s23, 294912
s_add_u32 s100, s100, s3
s_sub_u32 s23, 5, s23
s_mul_i32 s9, s23, 36864
s_mov_b32 s101, 2654208
s_mov_b32 s57, 0x05010400
s_mov_b32 s58, 0x07030602
s_mov_b32 s59, 0x05040100
s_mov_b32 s60, 0x07060302
s_waitcnt vmcnt(16)
ds_read2_b64 v[56:59], v111 offset0:0 offset1:16
ds_read2_b64 v[60:63], v111 offset0:32 offset1:48
ds_read2_b64 v[64:67], v111 offset0:64 offset1:80
ds_read2_b64 v[68:71], v111 offset0:96 offset1:112
tbuffer_load_format_d16_xyzw v[136:137], v4, s[16:19], s38 format:[BUF_DATA_FORMAT_32_32_32_32,BUF_NUM_FORMAT_UINT] offen
tbuffer_load_format_d16_xyzw v[138:139], v5, s[16:19], s38 format:[BUF_DATA_FORMAT_32_32_32_32,BUF_NUM_FORMAT_UINT] offen
s_waitcnt lgkmcnt(0)
v_perm_b32 v72, v58, v56, s57
v_perm_b32 v73, v58, v56, s58
v_perm_b32 v74, v62, v60, s57
v_perm_b32 v75, v62, v60, s58
v_perm_b32 v76, v66, v64, s57
v_perm_b32 v77, v66, v64, s58
v_perm_b32 v78, v70, v68, s57
v_perm_b32 v79, v70, v68, s58
v_perm_b32 v24, v74, v72, s59
v_perm_b32 v26, v74, v72, s60
v_perm_b32 v25, v78, v76, s59
v_perm_b32 v27, v78, v76, s60
v_perm_b32 v28, v75, v73, s59
v_perm_b32 v30, v75, v73, s60
v_perm_b32 v29, v79, v77, s59
v_perm_b32 v31, v79, v77, s60
tbuffer_load_format_d16_xyzw v[140:141], v6, s[16:19], s38 format:[BUF_DATA_FORMAT_32_32_32_32,BUF_NUM_FORMAT_UINT] offen
v_perm_b32 v72, v59, v57, s57
v_perm_b32 v73, v59, v57, s58
v_perm_b32 v74, v63, v61, s57
v_perm_b32 v75, v63, v61, s58
v_perm_b32 v76, v67, v65, s57
v_perm_b32 v77, v67, v65, s58
v_perm_b32 v78, v71, v69, s57
v_perm_b32 v79, v71, v69, s58
v_perm_b32 v32, v74, v72, s59
v_perm_b32 v34, v74, v72, s60
v_perm_b32 v33, v78, v76, s59
v_perm_b32 v35, v78, v76, s60
v_perm_b32 v36, v75, v73, s59
v_perm_b32 v38, v75, v73, s60
v_perm_b32 v37, v79, v77, s59
v_perm_b32 v39, v79, v77, s60
tbuffer_load_format_d16_xyzw v[142:143], v7, s[16:19], s38 format:[BUF_DATA_FORMAT_32_32_32_32,BUF_NUM_FORMAT_UINT] offen
s_branch L_main
.p2align 12
L_main:
L_page_0:
s_cbranch_execz L_hopback
s_waitcnt vmcnt(12)
v_lshl_or_b32 v40, v114, 8, v112
v_lshl_or_b32 v41, v118, 8, v116
v_lshl_or_b32 v42, v122, 8, v120
v_lshl_or_b32 v43, v126, 8, v124
v_lshl_or_b32 v44, v115, 8, v113
v_lshl_or_b32 v45, v119, 8, v117
v_lshl_or_b32 v46, v123, 8, v121
v_lshl_or_b32 v47, v127, 8, v125
v_perm_b32 v48, v41, v40, s59
v_perm_b32 v41, v41, v40, s60
v_perm_b32 v49, v43, v42, s59
v_perm_b32 v43, v43, v42, s60
v_perm_b32 v54, v45, v44, s59
v_perm_b32 v45, v45, v44, s60
v_perm_b32 v55, v47, v46, s59
v_perm_b32 v47, v47, v46, s60
v_perm_b32 v50, v25, v24, v48
v_perm_b32 v51, v27, v26, v48
v_perm_b32 v112, v51, v50, s57
v_perm_b32 v113, v51, v50, s58
v_perm_b32 v52, v25, v24, v49
v_perm_b32 v53, v27, v26, v49
v_perm_b32 v114, v53, v52, s57
v_perm_b32 v115, v53, v52, s58
ds_write_b128 v18, v[112:115] offset:0
v_perm_b32 v50, v29, v28, v41
v_perm_b32 v51, v31, v30, v41
v_perm_b32 v116, v51, v50, s57
v_perm_b32 v117, v51, v50, s58
v_perm_b32 v52, v29, v28, v43
v_perm_b32 v53, v31, v30, v43
v_perm_b32 v118, v53, v52, s57
v_perm_b32 v119, v53, v52, s58
ds_write_b128 v18, v[116:119] offset:1024
v_perm_b32 v50, v33, v32, v54
v_perm_b32 v51, v35, v34, v54
v_perm_b32 v120, v51, v50, s57
v_perm_b32 v121, v51, v50, s58
v_perm_b32 v52, v33, v32, v55
v_perm_b32 v53, v35, v34, v55
v_perm_b32 v122, v53, v52, s57
v_perm_b32 v123, v53, v52, s58
ds_write_b128 v18, v[120:123] offset:2048
v_perm_b32 v50, v37, v36, v45
v_perm_b32 v51, v39, v38, v45
v_perm_b32 v124, v51, v50, s57
v_perm_b32 v125, v51, v50, s58
v_perm_b32 v52, v37, v36, v47
v_perm_b32 v53, v39, v38, v47
v_perm_b32 v126, v53, v52, s57
v_perm_b32 v127, v53, v52, s58
ds_write_b128 v18, v[124:127] offset:3072
s_add_u32 m0, s55, 92160
s_nop 0
buffer_load_dwordx4 v8, s[12:15], s29 offen  lds
buffer_load_dwordx4 v9, s[12:15], s29 offen offset:1024  lds
buffer_load_dwordx4 v10, s[12:15], s29 offen offset:2048  lds
buffer_load_dwordx4 v11, s[12:15], s29 offen offset:3072  lds
s_waitcnt vmcnt(12) lgkmcnt(0)
s_barrier
tbuffer_load_format_d16_xyzw v[144:145], v0, s[16:19], s39 format:[BUF_DATA_FORMAT_32_32_32_32,BUF_NUM_FORMAT_UINT] offen
s_cmp_lg_u32 s1, 0
s_cbranch_scc1 L_notj_0
buffer_load_dword v96, v110, s[16:19], 0 offen
L_notj_0:
ds_read_b128 a[224:227], v14 offset:0
ds_read_b128 a[228:231], v14 offset:2048
tbuffer_load_format_d16_xyzw v[146:147], v1, s[16:19], s39 format:[BUF_DATA_FORMAT_32_32_32_32,BUF_NUM_FORMAT_UINT] offen
ds_read_b128 a[0:3], v19 offset:0
ds_read_b128 a[4:7], v19 offset:1024
ds_read_b128 a[8:11], v19 offset:2048
ds_read_b128 a[12:15], v19 offset:3072
ds_read_b128 a[232:235], v14 offset:4096
ds_read_b128 a[236:239], v14 offset:6144
ds_read_b128 a[240:243], v15 offset:0
ds_read_b128 a[244:247], v15 offset:2048
ds_read_b128 a[248:251], v15 offset:4096
ds_read_b128 a[252:255], v15 offset:6144
s_waitcnt lgkmcnt(10)
v_mfma_f32_16x16x32_bf16 v[56:59], a[224:227], v[112:115], 0
s_waitcnt vmcnt(6)
v_lshl_or_b32 v40, v130, 8, v128
v_lshl_or_b32 v41, v134, 8, v132
v_lshl_or_b32 v42, v138, 8, v136
v_mfma_f32_16x16x32_bf16 v[60:63], a[224:227], v[116:119], 0
v_lshl_or_b32 v43, v142, 8, v140
v_lshl_or_b32 v44, v131, 8, v129
v_lshl_or_b32 v45, v135, 8, v133
v_mfma_f32_16x16x32_bf16 v[64:67], a[224:227], v[120:123], 0
tbuffer_load_format_d16_xyzw v[148:149], v2, s[16:19], s39 format:[BUF_DATA_FORMAT_32_32_32_32,BUF_NUM_FORMAT_UINT] offen
v_lshl_or_b32 v46, v139, 8, v137
v_lshl_or_b32 v47, v143, 8, v141
v_perm_b32 v48, v41, v40, s59
v_mfma_f32_16x16x32_bf16 v[68:71], a[224:227], v[124:127], 0
v_perm_b32 v41, v41, v40, s60
v_perm_b32 v49, v43, v42, s59
v_perm_b32 v43, v43, v42, s60
v_mfma_f32_16x16x32_bf16 v[72:75], a[228:231], v[112:115], 0
tbuffer_load_format_d16_xyzw v[150:151], v3, s[16:19], s39 format:[BUF_DATA_FORMAT_32_32_32_32,BUF_NUM_FORMAT_UINT] offen
v_perm_b32 v54, v45, v44, s59
v_perm_b32 v45, v45, v44, s60
v_perm_b32 v55, v47, v46, s59
v_mfma_f32_16x16x32_bf16 v[76:79], a[228:231], v[116:119], 0
v_perm_b32 v47, v47, v46, s60
v_perm_b32 v50, v25, v24, v48
v_perm_b32 v51, v27, v26, v48
v_mfma_f32_16x16x32_bf16 v[80:83], a[228:231], v[120:123], 0
tbuffer_load_format_d16_xyzw v[152:153], v4, s[16:19], s39 format:[BUF_DATA_FORMAT_32_32_32_32,BUF_NUM_FORMAT_UINT] offen
v_perm_b32 v128, v51, v50, s57
v_perm_b32 v129, v51, v50, s58
v_perm_b32 v52, v25, v24, v49
v_mfma_f32_16x16x32_bf16 v[84:87], a[228:231], v[124:127], 0
v_perm_b32 v53, v27, v26, v49
v_perm_b32 v130, v53, v52, s57
v_perm_b32 v131, v53, v52, s58
s_waitcnt lgkmcnt(4)
v_mfma_f32_16x16x32_bf16 a[176:179], a[232:235], v[112:115], 0
ds_write_b128 v18, v[128:131] offset:16384
v_perm_b32 v50, v29, v28, v41
v_perm_b32 v51, v31, v30, v41
v_perm_b32 v132, v51, v50, s57
v_mfma_f32_16x16x32_bf16 a[180:183], a[232:235], v[116:119], 0
tbuffer_load_format_d16_xyzw v[154:155], v5, s[16:19], s39 format:[BUF_DATA_FORMAT_32_32_32_32,BUF_NUM_FORMAT_UINT] offen
v_perm_b32 v133, v51, v50, s58
v_perm_b32 v52, v29, v28, v43
v_perm_b32 v53, v31, v30, v43
v_mfma_f32_16x16x32_bf16 a[184:187], a[232:235], v[120:123], 0
v_perm_b32 v134, v53, v52, s57
v_perm_b32 v135, v53, v52, s58
v_perm_b32 v50, v33, v32, v54
v_mfma_f32_16x16x32_bf16 a[188:191], a[232:235], v[124:127], 0
tbuffer_load_format_d16_xyzw v[156:157], v6, s[16:19], s39 format:[BUF_DATA_FORMAT_32_32_32_32,BUF_NUM_FORMAT_UINT] offen
ds_write_b128 v18, v[132:135] offset:17408
v_perm_b32 v51, v35, v34, v54
v_perm_b32 v136, v51, v50, s57
v_perm_b32 v137, v51, v50, s58
v_mfma_f32_16x16x32_bf16 a[192:195], a[236:239], v[112:115], 0
v_perm_b32 v52, v33, v32, v55
v_perm_b32 v53, v35, v34, v55
v_perm_b32 v138, v53, v52, s57
v_mfma_f32_16x16x32_bf16 a[196:199], a[236:239], v[116:119], 0
tbuffer_load_format_d16_xyzw v[158:159], v7, s[16:19], s39 format:[BUF_DATA_FORMAT_32_32_32_32,BUF_NUM_FORMAT_UINT] offen
v_perm_b32 v139, v53, v52, s58
v_perm_b32 v50, v37, v36, v45
v_perm_b32 v51, v39, v38, v45
v_mfma_f32_16x16x32_bf16 a[200:203], a[236:239], v[120:123], 0
ds_write_b128 v18, v[136:139] offset:18432
v_perm_b32 v140, v51, v50, s57
v_perm_b32 v141, v51, v50, s58
v_perm_b32 v52, v37, v36, v47
v_mfma_f32_16x16x32_bf16 a[204:207], a[236:239], v[124:127], 0
s_add_u32 m0, s55, 110592
v_perm_b32 v53, v39, v38, v47
v_perm_b32 v142, v53, v52, s57
v_perm_b32 v143, v53, v52, s58
s_waitcnt lgkmcnt(5)
v_mfma_f32_16x16x32_bf16 v[56:59], a[240:243], a[0:3], v[56:59]
buffer_load_dwordx4 v8, s[12:15], s30 offen  lds
ds_write_b128 v18, v[140:143] offset:19456
v_mfma_f32_16x16x32_bf16 v[60:63], a[240:243], a[4:7], v[60:63]
v_mfma_f32_16x16x32_bf16 v[64:67], a[240:243], a[8:11], v[64:67]
buffer_load_dwordx4 v9, s[12:15], s30 offen offset:1024  lds
v_mfma_f32_16x16x32_bf16 v[68:71], a[240:243], a[12:15], v[68:71]
v_mfma_f32_16x16x32_bf16 v[72:75], a[244:247], a[0:3], v[72:75]
buffer_load_dwordx4 v10, s[12:15], s30 offen offset:2048  lds
v_mfma_f32_16x16x32_bf16 v[76:79], a[244:247], a[4:7], v[76:79]
v_mfma_f32_16x16x32_bf16 v[80:83], a[244:247], a[8:11], v[80:83]
v_mfma_f32_16x16x32_bf16 v[84:87], a[244:247], a[12:15], v[84:87]
buffer_load_dwordx4 v11, s[12:15], s30 offen offset:3072  lds
s_waitcnt vmcnt(12) lgkmcnt(0)
s_barrier
tbuffer_load_format_d16_xyzw v[160:161], v0, s[16:19], s40 format:[BUF_DATA_FORMAT_32_32_32_32,BUF_NUM_FORMAT_UINT] offen
s_cmp_lg_u32 s1, 1
s_cbranch_scc1 L_notj_1
buffer_load_dword v96, v110, s[16:19], 0 offen
L_notj_1:
ds_read_b128 a[224:227], v14 offset:18432
ds_read_b128 a[228:231], v14 offset:20480
tbuffer_load_format_d16_xyzw v[162:163], v1, s[16:19], s40 format:[BUF_DATA_FORMAT_32_32_32_32,BUF_NUM_FORMAT_UINT] offen
ds_read_b128 a[16:19], v19 offset:16384
ds_read_b128 a[20:23], v19 offset:17408
ds_read_b128 a[24:27], v19 offset:18432
ds_read_b128 a[28:31], v19 offset:19456
ds_read_b128 a[232:235], v14 offset:22528
ds_read_b128 a[236:239], v14 offset:24576
ds_read_b128 a[240:243], v15 offset:18432
ds_read_b128 a[244:247], v15 offset:20480
v_mfma_f32_16x16x32_bf16 a[176:179], a[248:251], a[0:3], a[176:179]
v_mfma_f32_16x16x32_bf16 a[180:183], a[248:251], a[4:7], a[180:183]
v_mfma_f32_16x16x32_bf16 a[184:187], a[248:251], a[8:11], a[184:187]
v_mfma_f32_16x16x32_bf16 a[188:191], a[248:251], a[12:15], a[188:191]
tbuffer_load_format_d16_xyzw v[164:165], v2, s[16:19], s40 format:[BUF_DATA_FORMAT_32_32_32_32,BUF_NUM_FORMAT_UINT] offen
ds_read_b128 a[248:251], v15 offset:22528
v_mfma_f32_16x16x32_bf16 a[192:195], a[252:255], a[0:3], a[192:195]
s_waitcnt vmcnt(7)
v_lshl_or_b32 v40, v146, 8, v144
v_lshl_or_b32 v41, v150, 8, v148
v_mfma_f32_16x16x32_bf16 a[196:199], a[252:255], a[4:7], a[196:199]
v_lshl_or_b32 v42, v154, 8, v152
v_lshl_or_b32 v43, v158, 8, v156
v_mfma_f32_16x16x32_bf16 a[200:203], a[252:255], a[8:11], a[200:203]
tbuffer_load_format_d16_xyzw v[166:167], v3, s[16:19], s40 format:[BUF_DATA_FORMAT_32_32_32_32,BUF_NUM_FORMAT_UINT] offen
v_lshl_or_b32 v44, v147, 8, v145
v_lshl_or_b32 v45, v151, 8, v149
v_mfma_f32_16x16x32_bf16 a[204:207], a[252:255], a[12:15], a[204:207]
v_lshl_or_b32 v46, v155, 8, v153
v_lshl_or_b32 v47, v159, 8, v157
ds_read_b128 a[252:255], v15 offset:24576
s_waitcnt lgkmcnt(10)
v_mfma_f32_16x16x32_bf16 v[56:59], a[224:227], v[128:131], v[56:59]
v_perm_b32 v48, v41, v40, s59
v_perm_b32 v41, v41, v40, s60
v_mfma_f32_16x16x32_bf16 v[60:63], a[224:227], v[132:135], v[60:63]
tbuffer_load_format_d16_xyzw v[168:169], v4, s[16:19], s40 format:[BUF_DATA_FORMAT_32_32_32_32,BUF_NUM_FORMAT_UINT] offen
v_perm_b32 v49, v43, v42, s59
v_perm_b32 v43, v43, v42, s60
v_mfma_f32_16x16x32_bf16 v[64:67], a[224:227], v[136:139], v[64:67]
v_perm_b32 v54, v45, v44, s59
v_perm_b32 v45, v45, v44, s60
v_mfma_f32_16x16x32_bf16 v[68:71], a[224:227], v[140:143], v[68:71]
v_perm_b32 v55, v47, v46, s59
v_perm_b32 v47, v47, v46, s60
v_mfma_f32_16x16x32_bf16 v[72:75], a[228:231], v[128:131], v[72:75]
tbuffer_load_format_d16_xyzw v[170:171], v5, s[16:19], s40 format:[BUF_DATA_FORMAT_32_32_32_32,BUF_NUM_FORMAT_UINT] offen
v_perm_b32 v50, v25, v24, v48
v_perm_b32 v51, v27, v26, v48
v_mfma_f32_16x16x32_bf16 v[76:79], a[228:231], v[132:135], v[76:79]
v_perm_b32 v144, v51, v50, s57
v_perm_b32 v145, v51, v50, s58
v_mfma_f32_16x16x32_bf16 v[80:83], a[228:231], v[136:139], v[80:83]
v_perm_b32 v52, v25, v24, v49
v_perm_b32 v53, v27, v26, v49
v_mfma_f32_16x16x32_bf16 v[84:87], a[228:231], v[140:143], v[84:87]
tbuffer_load_format_d16_xyzw v[172:173], v6, s[16:19], s40 format:[BUF_DATA_FORMAT_32_32_32_32,BUF_NUM_FORMAT_UINT] offen
v_perm_b32 v146, v53, v52, s57
v_perm_b32 v147, v53, v52, s58
s_waitcnt lgkmcnt(4)
v_mfma_f32_16x16x32_bf16 a[176:179], a[232:235], v[128:131], a[176:179]
ds_write_b128 v18, v[144:147] offset:0
v_perm_b32 v50, v29, v28, v41
v_perm_b32 v51, v31, v30, v41
v_mfma_f32_16x16x32_bf16 a[180:183], a[232:235], v[132:135], a[180:183]
v_perm_b32 v148, v51, v50, s57
v_perm_b32 v149, v51, v50, s58
v_mfma_f32_16x16x32_bf16 a[184:187], a[232:235], v[136:139], a[184:187]
tbuffer_load_format_d16_xyzw v[174:175], v7, s[16:19], s40 format:[BUF_DATA_FORMAT_32_32_32_32,BUF_NUM_FORMAT_UINT] offen
v_perm_b32 v52, v29, v28, v43
v_perm_b32 v53, v31, v30, v43
v_mfma_f32_16x16x32_bf16 a[188:191], a[232:235], v[140:143], a[188:191]
v_perm_b32 v150, v53, v52, s57
v_perm_b32 v151, v53, v52, s58
v_mfma_f32_16x16x32_bf16 a[192:195], a[236:239], v[128:131], a[192:195]
s_add_u32 m0, s55, 73728
ds_write_b128 v18, v[148:151] offset:1024
v_perm_b32 v50, v33, v32, v54
v_perm_b32 v51, v35, v34, v54
v_mfma_f32_16x16x32_bf16 a[196:199], a[236:239], v[132:135], a[196:199]
buffer_load_dwordx4 v8, s[12:15], s31 offen  lds
v_perm_b32 v152, v51, v50, s57
v_perm_b32 v153, v51, v50, s58
v_mfma_f32_16x16x32_bf16 a[200:203], a[236:239], v[136:139], a[200:203]
v_perm_b32 v52, v33, v32, v55
v_perm_b32 v53, v35, v34, v55
v_mfma_f32_16x16x32_bf16 a[204:207], a[236:239], v[140:143], a[204:207]
v_perm_b32 v154, v53, v52, s57
v_perm_b32 v155, v53, v52, s58
s_waitcnt lgkmcnt(4)
v_mfma_f32_16x16x32_bf16 v[56:59], a[240:243], a[16:19], v[56:59]
buffer_load_dwordx4 v9, s[12:15], s31 offen offset:1024  lds
ds_write_b128 v18, v[152:155] offset:2048
v_perm_b32 v50, v37, v36, v45
v_perm_b32 v51, v39, v38, v45
v_mfma_f32_16x16x32_bf16 v[60:63], a[240:243], a[20:23], v[60:63]
v_perm_b32 v156, v51, v50, s57
v_perm_b32 v157, v51, v50, s58
v_mfma_f32_16x16x32_bf16 v[64:67], a[240:243], a[24:27], v[64:67]
v_perm_b32 v52, v37, v36, v47
v_perm_b32 v53, v39, v38, v47
v_mfma_f32_16x16x32_bf16 v[68:71], a[240:243], a[28:31], v[68:71]
buffer_load_dwordx4 v10, s[12:15], s31 offen offset:2048  lds
v_perm_b32 v158, v53, v52, s57
v_perm_b32 v159, v53, v52, s58
v_mfma_f32_16x16x32_bf16 v[72:75], a[244:247], a[16:19], v[72:75]
ds_write_b128 v18, v[156:159] offset:3072
v_mfma_f32_16x16x32_bf16 v[76:79], a[244:247], a[20:23], v[76:79]
v_mfma_f32_16x16x32_bf16 v[80:83], a[244:247], a[24:27], v[80:83]
v_mfma_f32_16x16x32_bf16 v[84:87], a[244:247], a[28:31], v[84:87]
buffer_load_dwordx4 v11, s[12:15], s31 offen offset:3072  lds
s_waitcnt vmcnt(12) lgkmcnt(0)
s_barrier
tbuffer_load_format_d16_xyzw v[176:177], v0, s[16:19], s41 format:[BUF_DATA_FORMAT_32_32_32_32,BUF_NUM_FORMAT_UINT] offen
s_cmp_lg_u32 s1, 2
s_cbranch_scc1 L_notj_2
buffer_load_dword v96, v110, s[16:19], 0 offen
L_notj_2:
ds_read_b128 a[224:227], v14 offset:36864
ds_read_b128 a[228:231], v14 offset:38912
tbuffer_load_format_d16_xyzw v[178:179], v1, s[16:19], s41 format:[BUF_DATA_FORMAT_32_32_32_32,BUF_NUM_FORMAT_UINT] offen
ds_read_b128 a[32:35], v19 offset:0
ds_read_b128 a[36:39], v19 offset:1024
ds_read_b128 a[40:43], v19 offset:2048
ds_read_b128 a[44:47], v19 offset:3072
ds_read_b128 a[232:235], v14 offset:40960
ds_read_b128 a[236:239], v14 offset:43008
ds_read_b128 a[240:243], v15 offset:36864
ds_read_b128 a[244:247], v15 offset:38912
v_mfma_f32_16x16x32_bf16 a[176:179], a[248:251], a[16:19], a[176:179]
v_mfma_f32_16x16x32_bf16 a[180:183], a[248:251], a[20:23], a[180:183]
v_mfma_f32_16x16x32_bf16 a[184:187], a[248:251], a[24:27], a[184:187]
v_mfma_f32_16x16x32_bf16 a[188:191], a[248:251], a[28:31], a[188:191]
tbuffer_load_format_d16_xyzw v[180:181], v2, s[16:19], s41 format:[BUF_DATA_FORMAT_32_32_32_32,BUF_NUM_FORMAT_UINT] offen
ds_read_b128 a[248:251], v15 offset:40960
v_mfma_f32_16x16x32_bf16 a[192:195], a[252:255], a[16:19], a[192:195]
s_waitcnt vmcnt(7)
v_lshl_or_b32 v40, v162, 8, v160
v_lshl_or_b32 v41, v166, 8, v164
v_mfma_f32_16x16x32_bf16 a[196:199], a[252:255], a[20:23], a[196:199]
v_lshl_or_b32 v42, v170, 8, v168
v_lshl_or_b32 v43, v174, 8, v172
v_mfma_f32_16x16x32_bf16 a[200:203], a[252:255], a[24:27], a[200:203]
tbuffer_load_format_d16_xyzw v[182:183], v3, s[16:19], s41 format:[BUF_DATA_FORMAT_32_32_32_32,BUF_NUM_FORMAT_UINT] offen
v_lshl_or_b32 v44, v163, 8, v161
v_lshl_or_b32 v45, v167, 8, v165
v_mfma_f32_16x16x32_bf16 a[204:207], a[252:255], a[28:31], a[204:207]
v_lshl_or_b32 v46, v171, 8, v169
v_lshl_or_b32 v47, v175, 8, v173
ds_read_b128 a[252:255], v15 offset:43008
s_waitcnt lgkmcnt(10)
v_mfma_f32_16x16x32_bf16 v[56:59], a[224:227], v[144:147], v[56:59]
v_perm_b32 v48, v41, v40, s59
v_perm_b32 v41, v41, v40, s60
v_mfma_f32_16x16x32_bf16 v[60:63], a[224:227], v[148:151], v[60:63]
tbuffer_load_format_d16_xyzw v[184:185], v4, s[16:19], s41 format:[BUF_DATA_FORMAT_32_32_32_32,BUF_NUM_FORMAT_UINT] offen
v_perm_b32 v49, v43, v42, s59
v_perm_b32 v43, v43, v42, s60
v_mfma_f32_16x16x32_bf16 v[64:67], a[224:227], v[152:155], v[64:67]
v_perm_b32 v54, v45, v44, s59
v_perm_b32 v45, v45, v44, s60
v_mfma_f32_16x16x32_bf16 v[68:71], a[224:227], v[156:159], v[68:71]
v_perm_b32 v55, v47, v46, s59
v_perm_b32 v47, v47, v46, s60
v_mfma_f32_16x16x32_bf16 v[72:75], a[228:231], v[144:147], v[72:75]
tbuffer_load_format_d16_xyzw v[186:187], v5, s[16:19], s41 format:[BUF_DATA_FORMAT_32_32_32_32,BUF_NUM_FORMAT_UINT] offen
v_perm_b32 v50, v25, v24, v48
v_perm_b32 v51, v27, v26, v48
v_mfma_f32_16x16x32_bf16 v[76:79], a[228:231], v[148:151], v[76:79]
v_perm_b32 v160, v51, v50, s57
v_perm_b32 v161, v51, v50, s58
v_mfma_f32_16x16x32_bf16 v[80:83], a[228:231], v[152:155], v[80:83]
v_perm_b32 v52, v25, v24, v49
v_perm_b32 v53, v27, v26, v49
v_mfma_f32_16x16x32_bf16 v[84:87], a[228:231], v[156:159], v[84:87]
tbuffer_load_format_d16_xyzw v[188:189], v6, s[16:19], s41 format:[BUF_DATA_FORMAT_32_32_32_32,BUF_NUM_FORMAT_UINT] offen
v_perm_b32 v162, v53, v52, s57
v_perm_b32 v163, v53, v52, s58
s_waitcnt lgkmcnt(4)
v_mfma_f32_16x16x32_bf16 a[176:179], a[232:235], v[144:147], a[176:179]
ds_write_b128 v18, v[160:163] offset:16384
v_perm_b32 v50, v29, v28, v41
v_perm_b32 v51, v31, v30, v41
v_mfma_f32_16x16x32_bf16 a[180:183], a[232:235], v[148:151], a[180:183]
v_perm_b32 v164, v51, v50, s57
v_perm_b32 v165, v51, v50, s58
v_mfma_f32_16x16x32_bf16 a[184:187], a[232:235], v[152:155], a[184:187]
tbuffer_load_format_d16_xyzw v[190:191], v7, s[16:19], s41 format:[BUF_DATA_FORMAT_32_32_32_32,BUF_NUM_FORMAT_UINT] offen
v_perm_b32 v52, v29, v28, v43
v_perm_b32 v53, v31, v30, v43
v_mfma_f32_16x16x32_bf16 a[188:191], a[232:235], v[156:159], a[188:191]
v_perm_b32 v166, v53, v52, s57
v_perm_b32 v167, v53, v52, s58
v_mfma_f32_16x16x32_bf16 a[192:195], a[236:239], v[144:147], a[192:195]
s_add_u32 m0, s55, 92160
ds_write_b128 v18, v[164:167] offset:17408
v_perm_b32 v50, v33, v32, v54
v_perm_b32 v51, v35, v34, v54
v_mfma_f32_16x16x32_bf16 a[196:199], a[236:239], v[148:151], a[196:199]
buffer_load_dwordx4 v8, s[12:15], s32 offen  lds
v_perm_b32 v168, v51, v50, s57
v_perm_b32 v169, v51, v50, s58
v_mfma_f32_16x16x32_bf16 a[200:203], a[236:239], v[152:155], a[200:203]
v_perm_b32 v52, v33, v32, v55
v_perm_b32 v53, v35, v34, v55
v_mfma_f32_16x16x32_bf16 a[204:207], a[236:239], v[156:159], a[204:207]
v_perm_b32 v170, v53, v52, s57
v_perm_b32 v171, v53, v52, s58
s_waitcnt lgkmcnt(4)
v_mfma_f32_16x16x32_bf16 v[56:59], a[240:243], a[32:35], v[56:59]
buffer_load_dwordx4 v9, s[12:15], s32 offen offset:1024  lds
ds_write_b128 v18, v[168:171] offset:18432
v_perm_b32 v50, v37, v36, v45
v_perm_b32 v51, v39, v38, v45
v_mfma_f32_16x16x32_bf16 v[60:63], a[240:243], a[36:39], v[60:63]
v_perm_b32 v172, v51, v50, s57
v_perm_b32 v173, v51, v50, s58
v_mfma_f32_16x16x32_bf16 v[64:67], a[240:243], a[40:43], v[64:67]
v_perm_b32 v52, v37, v36, v47
v_perm_b32 v53, v39, v38, v47
v_mfma_f32_16x16x32_bf16 v[68:71], a[240:243], a[44:47], v[68:71]
buffer_load_dwordx4 v10, s[12:15], s32 offen offset:2048  lds
v_perm_b32 v174, v53, v52, s57
v_perm_b32 v175, v53, v52, s58
v_mfma_f32_16x16x32_bf16 v[72:75], a[244:247], a[32:35], v[72:75]
ds_write_b128 v18, v[172:175] offset:19456
v_mfma_f32_16x16x32_bf16 v[76:79], a[244:247], a[36:39], v[76:79]
v_mfma_f32_16x16x32_bf16 v[80:83], a[244:247], a[40:43], v[80:83]
v_mfma_f32_16x16x32_bf16 v[84:87], a[244:247], a[44:47], v[84:87]
buffer_load_dwordx4 v11, s[12:15], s32 offen offset:3072  lds
s_waitcnt vmcnt(12) lgkmcnt(0)
s_barrier
tbuffer_load_format_d16_xyzw v[192:193], v0, s[16:19], s42 format:[BUF_DATA_FORMAT_32_32_32_32,BUF_NUM_FORMAT_UINT] offen
s_cmp_lg_u32 s1, 3
s_cbranch_scc1 L_notj_3
buffer_load_dword v96, v110, s[16:19], 0 offen
L_notj_3:
ds_read_b128 a[224:227], v14 offset:0
ds_read_b128 a[228:231], v14 offset:2048
tbuffer_load_format_d16_xyzw v[194:195], v1, s[16:19], s42 format:[BUF_DATA_FORMAT_32_32_32_32,BUF_NUM_FORMAT_UINT] offen
ds_read_b128 a[48:51], v19 offset:16384
ds_read_b128 a[52:55], v19 offset:17408
ds_read_b128 a[56:59], v19 offset:18432
ds_read_b128 a[60:63], v19 offset:19456
ds_read_b128 a[232:235], v14 offset:4096
ds_read_b128 a[236:239], v14 offset:6144
ds_read_b128 a[240:243], v15 offset:0
ds_read_b128 a[244:247], v15 offset:2048
v_mfma_f32_16x16x32_bf16 a[176:179], a[248:251], a[32:35], a[176:179]
v_mfma_f32_16x16x32_bf16 a[180:183], a[248:251], a[36:39], a[180:183]
v_mfma_f32_16x16x32_bf16 a[184:187], a[248:251], a[40:43], a[184:187]
v_mfma_f32_16x16x32_bf16 a[188:191], a[248:251], a[44:47], a[188:191]
tbuffer_load_format_d16_xyzw v[196:197], v2, s[16:19], s42 format:[BUF_DATA_FORMAT_32_32_32_32,BUF_NUM_FORMAT_UINT] offen
ds_read_b128 a[248:251], v15 offset:4096
v_mfma_f32_16x16x32_bf16 a[192:195], a[252:255], a[32:35], a[192:195]
s_waitcnt vmcnt(7)
v_lshl_or_b32 v40, v178, 8, v176
v_lshl_or_b32 v41, v182, 8, v180
v_mfma_f32_16x16x32_bf16 a[196:199], a[252:255], a[36:39], a[196:199]
v_lshl_or_b32 v42, v186, 8, v184
v_lshl_or_b32 v43, v190, 8, v188
v_mfma_f32_16x16x32_bf16 a[200:203], a[252:255], a[40:43], a[200:203]
tbuffer_load_format_d16_xyzw v[198:199], v3, s[16:19], s42 format:[BUF_DATA_FORMAT_32_32_32_32,BUF_NUM_FORMAT_UINT] offen
v_lshl_or_b32 v44, v179, 8, v177
v_lshl_or_b32 v45, v183, 8, v181
v_mfma_f32_16x16x32_bf16 a[204:207], a[252:255], a[44:47], a[204:207]
v_lshl_or_b32 v46, v187, 8, v185
v_lshl_or_b32 v47, v191, 8, v189
ds_read_b128 a[252:255], v15 offset:6144
s_waitcnt lgkmcnt(10)
v_mfma_f32_16x16x32_bf16 v[56:59], a[224:227], v[160:163], v[56:59]
v_perm_b32 v48, v41, v40, s59
v_perm_b32 v41, v41, v40, s60
v_mfma_f32_16x16x32_bf16 v[60:63], a[224:227], v[164:167], v[60:63]
tbuffer_load_format_d16_xyzw v[200:201], v4, s[16:19], s42 format:[BUF_DATA_FORMAT_32_32_32_32,BUF_NUM_FORMAT_UINT] offen
v_perm_b32 v49, v43, v42, s59
v_perm_b32 v43, v43, v42, s60
v_mfma_f32_16x16x32_bf16 v[64:67], a[224:227], v[168:171], v[64:67]
v_perm_b32 v54, v45, v44, s59
v_perm_b32 v45, v45, v44, s60
v_mfma_f32_16x16x32_bf16 v[68:71], a[224:227], v[172:175], v[68:71]
v_perm_b32 v55, v47, v46, s59
v_perm_b32 v47, v47, v46, s60
v_mfma_f32_16x16x32_bf16 v[72:75], a[228:231], v[160:163], v[72:75]
tbuffer_load_format_d16_xyzw v[202:203], v5, s[16:19], s42 format:[BUF_DATA_FORMAT_32_32_32_32,BUF_NUM_FORMAT_UINT] offen
v_perm_b32 v50, v25, v24, v48
v_perm_b32 v51, v27, v26, v48
v_mfma_f32_16x16x32_bf16 v[76:79], a[228:231], v[164:167], v[76:79]
v_perm_b32 v176, v51, v50, s57
v_perm_b32 v177, v51, v50, s58
v_mfma_f32_16x16x32_bf16 v[80:83], a[228:231], v[168:171], v[80:83]
v_perm_b32 v52, v25, v24, v49
v_perm_b32 v53, v27, v26, v49
v_mfma_f32_16x16x32_bf16 v[84:87], a[228:231], v[172:175], v[84:87]
tbuffer_load_format_d16_xyzw v[204:205], v6, s[16:19], s42 format:[BUF_DATA_FORMAT_32_32_32_32,BUF_NUM_FORMAT_UINT] offen
v_perm_b32 v178, v53, v52, s57
v_perm_b32 v179, v53, v52, s58
s_waitcnt lgkmcnt(4)
v_mfma_f32_16x16x32_bf16 a[176:179], a[232:235], v[160:163], a[176:179]
ds_write_b128 v18, v[176:179] offset:0
v_perm_b32 v50, v29, v28, v41
v_perm_b32 v51, v31, v30, v41
v_mfma_f32_16x16x32_bf16 a[180:183], a[232:235], v[164:167], a[180:183]
v_perm_b32 v180, v51, v50, s57
v_perm_b32 v181, v51, v50, s58
v_mfma_f32_16x16x32_bf16 a[184:187], a[232:235], v[168:171], a[184:187]
tbuffer_load_format_d16_xyzw v[206:207], v7, s[16:19], s42 format:[BUF_DATA_FORMAT_32_32_32_32,BUF_NUM_FORMAT_UINT] offen
v_perm_b32 v52, v29, v28, v43
v_perm_b32 v53, v31, v30, v43
v_mfma_f32_16x16x32_bf16 a[188:191], a[232:235], v[172:175], a[188:191]
v_perm_b32 v182, v53, v52, s57
v_perm_b32 v183, v53, v52, s58
v_mfma_f32_16x16x32_bf16 a[192:195], a[236:239], v[160:163], a[192:195]
s_add_u32 m0, s55, 110592
ds_write_b128 v18, v[180:183] offset:1024
v_perm_b32 v50, v33, v32, v54
v_perm_b32 v51, v35, v34, v54
v_mfma_f32_16x16x32_bf16 a[196:199], a[236:239], v[164:167], a[196:199]
buffer_load_dwordx4 v8, s[12:15], s33 offen  lds
v_perm_b32 v184, v51, v50, s57
v_perm_b32 v185, v51, v50, s58
v_mfma_f32_16x16x32_bf16 a[200:203], a[236:239], v[168:171], a[200:203]
v_perm_b32 v52, v33, v32, v55
v_perm_b32 v53, v35, v34, v55
v_mfma_f32_16x16x32_bf16 a[204:207], a[236:239], v[172:175], a[204:207]
v_perm_b32 v186, v53, v52, s57
v_perm_b32 v187, v53, v52, s58
s_waitcnt lgkmcnt(4)
v_mfma_f32_16x16x32_bf16 v[56:59], a[240:243], a[48:51], v[56:59]
buffer_load_dwordx4 v9, s[12:15], s33 offen offset:1024  lds
ds_write_b128 v18, v[184:187] offset:2048
v_perm_b32 v50, v37, v36, v45
v_perm_b32 v51, v39, v38, v45
v_mfma_f32_16x16x32_bf16 v[60:63], a[240:243], a[52:55], v[60:63]
v_perm_b32 v188, v51, v50, s57
v_perm_b32 v189, v51, v50, s58
v_mfma_f32_16x16x32_bf16 v[64:67], a[240:243], a[56:59], v[64:67]
v_perm_b32 v52, v37, v36, v47
v_perm_b32 v53, v39, v38, v47
v_mfma_f32_16x16x32_bf16 v[68:71], a[240:243], a[60:63], v[68:71]
buffer_load_dwordx4 v10, s[12:15], s33 offen offset:2048  lds
v_perm_b32 v190, v53, v52, s57
v_perm_b32 v191, v53, v52, s58
v_mfma_f32_16x16x32_bf16 v[72:75], a[244:247], a[48:51], v[72:75]
ds_write_b128 v18, v[188:191] offset:3072
v_mfma_f32_16x16x32_bf16 v[76:79], a[244:247], a[52:55], v[76:79]
v_mfma_f32_16x16x32_bf16 v[80:83], a[244:247], a[56:59], v[80:83]
v_mfma_f32_16x16x32_bf16 v[84:87], a[244:247], a[60:63], v[84:87]
buffer_load_dwordx4 v11, s[12:15], s33 offen offset:3072  lds
s_waitcnt vmcnt(12) lgkmcnt(0)
s_barrier
tbuffer_load_format_d16_xyzw v[208:209], v0, s[16:19], s43 format:[BUF_DATA_FORMAT_32_32_32_32,BUF_NUM_FORMAT_UINT] offen
ds_read_b128 a[224:227], v14 offset:18432
ds_read_b128 a[228:231], v14 offset:20480
tbuffer_load_format_d16_xyzw v[210:211], v1, s[16:19], s43 format:[BUF_DATA_FORMAT_32_32_32_32,BUF_NUM_FORMAT_UINT] offen
ds_read_b128 a[64:67], v19 offset:0
L_page_1:
s_cbranch_execz L_hopback
ds_read_b128 a[68:71], v19 offset:1024
ds_read_b128 a[72:75], v19 offset:2048
ds_read_b128 a[76:79], v19 offset:3072
ds_read_b128 a[232:235], v14 offset:22528
ds_read_b128 a[236:239], v14 offset:24576
ds_read_b128 a[240:243], v15 offset:18432
ds_read_b128 a[244:247], v15 offset:20480
v_mfma_f32_16x16x32_bf16 a[176:179], a[248:251], a[48:51], a[176:179]
v_mfma_f32_16x16x32_bf16 a[180:183], a[248:251], a[52:55], a[180:183]
v_mfma_f32_16x16x32_bf16 a[184:187], a[248:251], a[56:59], a[184:187]
v_mfma_f32_16x16x32_bf16 a[188:191], a[248:251], a[60:63], a[188:191]
tbuffer_load_format_d16_xyzw v[212:213], v2, s[16:19], s43 format:[BUF_DATA_FORMAT_32_32_32_32,BUF_NUM_FORMAT_UINT] offen
ds_read_b128 a[248:251], v15 offset:22528
v_mfma_f32_16x16x32_bf16 a[192:195], a[252:255], a[48:51], a[192:195]
s_waitcnt vmcnt(7)
v_lshl_or_b32 v40, v194, 8, v192
v_lshl_or_b32 v41, v198, 8, v196
v_mfma_f32_16x16x32_bf16 a[196:199], a[252:255], a[52:55], a[196:199]
v_lshl_or_b32 v42, v202, 8, v200
v_lshl_or_b32 v43, v206, 8, v204
v_mfma_f32_16x16x32_bf16 a[200:203], a[252:255], a[56:59], a[200:203]
tbuffer_load_format_d16_xyzw v[214:215], v3, s[16:19], s43 format:[BUF_DATA_FORMAT_32_32_32_32,BUF_NUM_FORMAT_UINT] offen
v_lshl_or_b32 v44, v195, 8, v193
v_lshl_or_b32 v45, v199, 8, v197
v_mfma_f32_16x16x32_bf16 a[204:207], a[252:255], a[60:63], a[204:207]
v_lshl_or_b32 v46, v203, 8, v201
v_lshl_or_b32 v47, v207, 8, v205
ds_read_b128 a[252:255], v15 offset:24576
s_waitcnt lgkmcnt(10)
v_mfma_f32_16x16x32_bf16 v[56:59], a[224:227], v[176:179], v[56:59]
v_perm_b32 v48, v41, v40, s59
v_perm_b32 v41, v41, v40, s60
v_mfma_f32_16x16x32_bf16 v[60:63], a[224:227], v[180:183], v[60:63]
tbuffer_load_format_d16_xyzw v[216:217], v4, s[16:19], s43 format:[BUF_DATA_FORMAT_32_32_32_32,BUF_NUM_FORMAT_UINT] offen
v_perm_b32 v49, v43, v42, s59
v_perm_b32 v43, v43, v42, s60
v_mfma_f32_16x16x32_bf16 v[64:67], a[224:227], v[184:187], v[64:67]
v_perm_b32 v54, v45, v44, s59
v_perm_b32 v45, v45, v44, s60
v_mfma_f32_16x16x32_bf16 v[68:71], a[224:227], v[188:191], v[68:71]
v_perm_b32 v55, v47, v46, s59
v_perm_b32 v47, v47, v46, s60
v_mfma_f32_16x16x32_bf16 v[72:75], a[228:231], v[176:179], v[72:75]
tbuffer_load_format_d16_xyzw v[218:219], v5, s[16:19], s43 format:[BUF_DATA_FORMAT_32_32_32_32,BUF_NUM_FORMAT_UINT] offen
v_perm_b32 v50, v25, v24, v48
v_perm_b32 v51, v27, v26, v48
v_mfma_f32_16x16x32_bf16 v[76:79], a[228:231], v[180:183], v[76:79]
v_perm_b32 v192, v51, v50, s57
v_perm_b32 v193, v51, v50, s58
v_mfma_f32_16x16x32_bf16 v[80:83], a[228:231], v[184:187], v[80:83]
v_perm_b32 v52, v25, v24, v49
v_perm_b32 v53, v27, v26, v49
v_mfma_f32_16x16x32_bf16 v[84:87], a[228:231], v[188:191], v[84:87]
tbuffer_load_format_d16_xyzw v[220:221], v6, s[16:19], s43 format:[BUF_DATA_FORMAT_32_32_32_32,BUF_NUM_FORMAT_UINT] offen
v_perm_b32 v194, v53, v52, s57
v_perm_b32 v195, v53, v52, s58
s_waitcnt lgkmcnt(4)
v_mfma_f32_16x16x32_bf16 a[176:179], a[232:235], v[176:179], a[176:179]
ds_write_b128 v18, v[192:195] offset:16384
v_perm_b32 v50, v29, v28, v41
v_perm_b32 v51, v31, v30, v41
v_mfma_f32_16x16x32_bf16 a[180:183], a[232:235], v[180:183], a[180:183]
v_perm_b32 v196, v51, v50, s57
v_perm_b32 v197, v51, v50, s58
v_mfma_f32_16x16x32_bf16 a[184:187], a[232:235], v[184:187], a[184:187]
tbuffer_load_format_d16_xyzw v[222:223], v7, s[16:19], s43 format:[BUF_DATA_FORMAT_32_32_32_32,BUF_NUM_FORMAT_UINT] offen
v_perm_b32 v52, v29, v28, v43
v_perm_b32 v53, v31, v30, v43
v_mfma_f32_16x16x32_bf16 a[188:191], a[232:235], v[188:191], a[188:191]
v_perm_b32 v198, v53, v52, s57
v_perm_b32 v199, v53, v52, s58
v_mfma_f32_16x16x32_bf16 a[192:195], a[236:239], v[176:179], a[192:195]
s_add_u32 m0, s55, 73728
ds_write_b128 v18, v[196:199] offset:17408
v_perm_b32 v50, v33, v32, v54
v_perm_b32 v51, v35, v34, v54
v_mfma_f32_16x16x32_bf16 a[196:199], a[236:239], v[180:183], a[196:199]
buffer_load_dwordx4 v8, s[12:15], s34 offen  lds
v_perm_b32 v200, v51, v50, s57
v_perm_b32 v201, v51, v50, s58
v_mfma_f32_16x16x32_bf16 a[200:203], a[236:239], v[184:187], a[200:203]
v_perm_b32 v52, v33, v32, v55
v_perm_b32 v53, v35, v34, v55
v_mfma_f32_16x16x32_bf16 a[204:207], a[236:239], v[188:191], a[204:207]
v_perm_b32 v202, v53, v52, s57
v_perm_b32 v203, v53, v52, s58
s_waitcnt lgkmcnt(4)
v_mfma_f32_16x16x32_bf16 v[56:59], a[240:243], a[64:67], v[56:59]
buffer_load_dwordx4 v9, s[12:15], s34 offen offset:1024  lds
ds_write_b128 v18, v[200:203] offset:18432
v_perm_b32 v50, v37, v36, v45
v_perm_b32 v51, v39, v38, v45
v_mfma_f32_16x16x32_bf16 v[60:63], a[240:243], a[68:71], v[60:63]
v_perm_b32 v204, v51, v50, s57
v_perm_b32 v205, v51, v50, s58
v_mfma_f32_16x16x32_bf16 v[64:67], a[240:243], a[72:75], v[64:67]
v_perm_b32 v52, v37, v36, v47
v_perm_b32 v53, v39, v38, v47
v_mfma_f32_16x16x32_bf16 v[68:71], a[240:243], a[76:79], v[68:71]
buffer_load_dwordx4 v10, s[12:15], s34 offen offset:2048  lds
v_perm_b32 v206, v53, v52, s57
v_perm_b32 v207, v53, v52, s58
v_mfma_f32_16x16x32_bf16 v[72:75], a[244:247], a[64:67], v[72:75]
ds_write_b128 v18, v[204:207] offset:19456
v_mfma_f32_16x16x32_bf16 v[76:79], a[244:247], a[68:71], v[76:79]
v_mfma_f32_16x16x32_bf16 v[80:83], a[244:247], a[72:75], v[80:83]
v_mfma_f32_16x16x32_bf16 v[84:87], a[244:247], a[76:79], v[84:87]
buffer_load_dwordx4 v11, s[12:15], s34 offen offset:3072  lds
s_waitcnt vmcnt(12) lgkmcnt(0)
s_barrier
tbuffer_load_format_d16_xyzw v[224:225], v0, s[16:19], s44 format:[BUF_DATA_FORMAT_32_32_32_32,BUF_NUM_FORMAT_UINT] offen
ds_read_b128 a[224:227], v14 offset:36864
ds_read_b128 a[228:231], v14 offset:38912
tbuffer_load_format_d16_xyzw v[226:227], v1, s[16:19], s44 format:[BUF_DATA_FORMAT_32_32_32_32,BUF_NUM_FORMAT_UINT] offen
ds_read_b128 a[80:83], v19 offset:16384
ds_read_b128 a[84:87], v19 offset:17408
ds_read_b128 a[88:91], v19 offset:18432
ds_read_b128 a[92:95], v19 offset:19456
ds_read_b128 a[232:235], v14 offset:40960
ds_read_b128 a[236:239], v14 offset:43008
ds_read_b128 a[240:243], v15 offset:36864
ds_read_b128 a[244:247], v15 offset:38912
v_mfma_f32_16x16x32_bf16 a[176:179], a[248:251], a[64:67], a[176:179]
v_mfma_f32_16x16x32_bf16 a[180:183], a[248:251], a[68:71], a[180:183]
v_mfma_f32_16x16x32_bf16 a[184:187], a[248:251], a[72:75], a[184:187]
v_mfma_f32_16x16x32_bf16 a[188:191], a[248:251], a[76:79], a[188:191]
tbuffer_load_format_d16_xyzw v[228:229], v2, s[16:19], s44 format:[BUF_DATA_FORMAT_32_32_32_32,BUF_NUM_FORMAT_UINT] offen
ds_read_b128 a[248:251], v15 offset:40960
v_mfma_f32_16x16x32_bf16 a[192:195], a[252:255], a[64:67], a[192:195]
s_waitcnt vmcnt(7)
v_lshl_or_b32 v40, v210, 8, v208
v_lshl_or_b32 v41, v214, 8, v212
v_mfma_f32_16x16x32_bf16 a[196:199], a[252:255], a[68:71], a[196:199]
v_lshl_or_b32 v42, v218, 8, v216
v_lshl_or_b32 v43, v222, 8, v220
v_mfma_f32_16x16x32_bf16 a[200:203], a[252:255], a[72:75], a[200:203]
tbuffer_load_format_d16_xyzw v[230:231], v3, s[16:19], s44 format:[BUF_DATA_FORMAT_32_32_32_32,BUF_NUM_FORMAT_UINT] offen
v_lshl_or_b32 v44, v211, 8, v209
v_lshl_or_b32 v45, v215, 8, v213
v_mfma_f32_16x16x32_bf16 a[204:207], a[252:255], a[76:79], a[204:207]
v_lshl_or_b32 v46, v219, 8, v217
v_lshl_or_b32 v47, v223, 8, v221
ds_read_b128 a[252:255], v15 offset:43008
s_waitcnt lgkmcnt(10)
v_mfma_f32_16x16x32_bf16 v[56:59], a[224:227], v[192:195], v[56:59]
v_perm_b32 v48, v41, v40, s59
v_perm_b32 v41, v41, v40, s60
v_mfma_f32_16x16x32_bf16 v[60:63], a[224:227], v[196:199], v[60:63]
tbuffer_load_format_d16_xyzw v[232:233], v4, s[16:19], s44 format:[BUF_DATA_FORMAT_32_32_32_32,BUF_NUM_FORMAT_UINT] offen
v_perm_b32 v49, v43, v42, s59
v_perm_b32 v43, v43, v42, s60
v_mfma_f32_16x16x32_bf16 v[64:67], a[224:227], v[200:203], v[64:67]
v_perm_b32 v54, v45, v44, s59
v_perm_b32 v45, v45, v44, s60
v_mfma_f32_16x16x32_bf16 v[68:71], a[224:227], v[204:207], v[68:71]
v_perm_b32 v55, v47, v46, s59
v_perm_b32 v47, v47, v46, s60
v_mfma_f32_16x16x32_bf16 v[72:75], a[228:231], v[192:195], v[72:75]
tbuffer_load_format_d16_xyzw v[234:235], v5, s[16:19], s44 format:[BUF_DATA_FORMAT_32_32_32_32,BUF_NUM_FORMAT_UINT] offen
v_perm_b32 v50, v25, v24, v48
v_perm_b32 v51, v27, v26, v48
v_mfma_f32_16x16x32_bf16 v[76:79], a[228:231], v[196:199], v[76:79]
v_perm_b32 v208, v51, v50, s57
v_perm_b32 v209, v51, v50, s58
v_mfma_f32_16x16x32_bf16 v[80:83], a[228:231], v[200:203], v[80:83]
v_perm_b32 v52, v25, v24, v49
v_perm_b32 v53, v27, v26, v49
v_mfma_f32_16x16x32_bf16 v[84:87], a[228:231], v[204:207], v[84:87]
tbuffer_load_format_d16_xyzw v[236:237], v6, s[16:19], s44 format:[BUF_DATA_FORMAT_32_32_32_32,BUF_NUM_FORMAT_UINT] offen
v_perm_b32 v210, v53, v52, s57
v_perm_b32 v211, v53, v52, s58
s_waitcnt lgkmcnt(4)
v_mfma_f32_16x16x32_bf16 a[176:179], a[232:235], v[192:195], a[176:179]
ds_write_b128 v18, v[208:211] offset:0
v_perm_b32 v50, v29, v28, v41
v_perm_b32 v51, v31, v30, v41
v_mfma_f32_16x16x32_bf16 a[180:183], a[232:235], v[196:199], a[180:183]
v_perm_b32 v212, v51, v50, s57
v_perm_b32 v213, v51, v50, s58
v_mfma_f32_16x16x32_bf16 a[184:187], a[232:235], v[200:203], a[184:187]
tbuffer_load_format_d16_xyzw v[238:239], v7, s[16:19], s44 format:[BUF_DATA_FORMAT_32_32_32_32,BUF_NUM_FORMAT_UINT] offen
v_perm_b32 v52, v29, v28, v43
v_perm_b32 v53, v31, v30, v43
v_mfma_f32_16x16x32_bf16 a[188:191], a[232:235], v[204:207], a[188:191]
v_perm_b32 v214, v53, v52, s57
v_perm_b32 v215, v53, v52, s58
v_mfma_f32_16x16x32_bf16 a[192:195], a[236:239], v[192:195], a[192:195]
s_add_u32 m0, s55, 92160
ds_write_b128 v18, v[212:215] offset:1024
v_perm_b32 v50, v33, v32, v54
v_perm_b32 v51, v35, v34, v54
v_mfma_f32_16x16x32_bf16 a[196:199], a[236:239], v[196:199], a[196:199]
buffer_load_dwordx4 v8, s[12:15], s35 offen  lds
v_perm_b32 v216, v51, v50, s57
v_perm_b32 v217, v51, v50, s58
v_mfma_f32_16x16x32_bf16 a[200:203], a[236:239], v[200:203], a[200:203]
v_perm_b32 v52, v33, v32, v55
v_perm_b32 v53, v35, v34, v55
v_mfma_f32_16x16x32_bf16 a[204:207], a[236:239], v[204:207], a[204:207]
v_perm_b32 v218, v53, v52, s57
v_perm_b32 v219, v53, v52, s58
s_waitcnt lgkmcnt(4)
v_mfma_f32_16x16x32_bf16 v[56:59], a[240:243], a[80:83], v[56:59]
buffer_load_dwordx4 v9, s[12:15], s35 offen offset:1024  lds
ds_write_b128 v18, v[216:219] offset:2048
v_perm_b32 v50, v37, v36, v45
v_perm_b32 v51, v39, v38, v45
v_mfma_f32_16x16x32_bf16 v[60:63], a[240:243], a[84:87], v[60:63]
v_perm_b32 v220, v51, v50, s57
v_perm_b32 v221, v51, v50, s58
v_mfma_f32_16x16x32_bf16 v[64:67], a[240:243], a[88:91], v[64:67]
v_perm_b32 v52, v37, v36, v47
v_perm_b32 v53, v39, v38, v47
v_mfma_f32_16x16x32_bf16 v[68:71], a[240:243], a[92:95], v[68:71]
buffer_load_dwordx4 v10, s[12:15], s35 offen offset:2048  lds
v_perm_b32 v222, v53, v52, s57
v_perm_b32 v223, v53, v52, s58
v_mfma_f32_16x16x32_bf16 v[72:75], a[244:247], a[80:83], v[72:75]
ds_write_b128 v18, v[220:223] offset:3072
v_mfma_f32_16x16x32_bf16 v[76:79], a[244:247], a[84:87], v[76:79]
v_mfma_f32_16x16x32_bf16 v[80:83], a[244:247], a[88:91], v[80:83]
v_mfma_f32_16x16x32_bf16 v[84:87], a[244:247], a[92:95], v[84:87]
buffer_load_dwordx4 v11, s[12:15], s35 offen offset:3072  lds
s_waitcnt vmcnt(12) lgkmcnt(0)
s_barrier
tbuffer_load_format_d16_xyzw v[240:241], v0, s[16:19], s45 format:[BUF_DATA_FORMAT_32_32_32_32,BUF_NUM_FORMAT_UINT] offen
ds_read_b128 a[224:227], v14 offset:0
ds_read_b128 a[228:231], v14 offset:2048
tbuffer_load_format_d16_xyzw v[242:243], v1, s[16:19], s45 format:[BUF_DATA_FORMAT_32_32_32_32,BUF_NUM_FORMAT_UINT] offen
ds_read_b128 a[96:99], v19 offset:0
ds_read_b128 a[100:103], v19 offset:1024
ds_read_b128 a[104:107], v19 offset:2048
ds_read_b128 a[108:111], v19 offset:3072
ds_read_b128 a[232:235], v14 offset:4096
ds_read_b128 a[236:239], v14 offset:6144
ds_read_b128 a[240:243], v15 offset:0
ds_read_b128 a[244:247], v15 offset:2048
v_mfma_f32_16x16x32_bf16 a[176:179], a[248:251], a[80:83], a[176:179]
v_mfma_f32_16x16x32_bf16 a[180:183], a[248:251], a[84:87], a[180:183]
v_mfma_f32_16x16x32_bf16 a[184:187], a[248:251], a[88:91], a[184:187]
v_mfma_f32_16x16x32_bf16 a[188:191], a[248:251], a[92:95], a[188:191]
tbuffer_load_format_d16_xyzw v[244:245], v2, s[16:19], s45 format:[BUF_DATA_FORMAT_32_32_32_32,BUF_NUM_FORMAT_UINT] offen
ds_read_b128 a[248:251], v15 offset:4096
v_mfma_f32_16x16x32_bf16 a[192:195], a[252:255], a[80:83], a[192:195]
s_waitcnt vmcnt(7)
v_lshl_or_b32 v40, v226, 8, v224
v_lshl_or_b32 v41, v230, 8, v228
v_mfma_f32_16x16x32_bf16 a[196:199], a[252:255], a[84:87], a[196:199]
v_lshl_or_b32 v42, v234, 8, v232
v_lshl_or_b32 v43, v238, 8, v236
v_mfma_f32_16x16x32_bf16 a[200:203], a[252:255], a[88:91], a[200:203]
tbuffer_load_format_d16_xyzw v[246:247], v3, s[16:19], s45 format:[BUF_DATA_FORMAT_32_32_32_32,BUF_NUM_FORMAT_UINT] offen
v_lshl_or_b32 v44, v227, 8, v225
v_lshl_or_b32 v45, v231, 8, v229
v_mfma_f32_16x16x32_bf16 a[204:207], a[252:255], a[92:95], a[204:207]
v_lshl_or_b32 v46, v235, 8, v233
v_lshl_or_b32 v47, v239, 8, v237
ds_read_b128 a[252:255], v15 offset:6144
s_waitcnt lgkmcnt(10)
v_mfma_f32_16x16x32_bf16 v[56:59], a[224:227], v[208:211], v[56:59]
v_perm_b32 v48, v41, v40, s59
v_perm_b32 v41, v41, v40, s60
v_mfma_f32_16x16x32_bf16 v[60:63], a[224:227], v[212:215], v[60:63]
tbuffer_load_format_d16_xyzw v[248:249], v4, s[16:19], s45 format:[BUF_DATA_FORMAT_32_32_32_32,BUF_NUM_FORMAT_UINT] offen
v_perm_b32 v49, v43, v42, s59
v_perm_b32 v43, v43, v42, s60
v_mfma_f32_16x16x32_bf16 v[64:67], a[224:227], v[216:219], v[64:67]
v_perm_b32 v54, v45, v44, s59
v_perm_b32 v45, v45, v44, s60
v_mfma_f32_16x16x32_bf16 v[68:71], a[224:227], v[220:223], v[68:71]
v_perm_b32 v55, v47, v46, s59
v_perm_b32 v47, v47, v46, s60
v_mfma_f32_16x16x32_bf16 v[72:75], a[228:231], v[208:211], v[72:75]
tbuffer_load_format_d16_xyzw v[250:251], v5, s[16:19], s45 format:[BUF_DATA_FORMAT_32_32_32_32,BUF_NUM_FORMAT_UINT] offen
v_perm_b32 v50, v25, v24, v48
v_perm_b32 v51, v27, v26, v48
v_mfma_f32_16x16x32_bf16 v[76:79], a[228:231], v[212:215], v[76:79]
v_perm_b32 v224, v51, v50, s57
v_perm_b32 v225, v51, v50, s58
v_mfma_f32_16x16x32_bf16 v[80:83], a[228:231], v[216:219], v[80:83]
v_perm_b32 v52, v25, v24, v49
v_perm_b32 v53, v27, v26, v49
v_mfma_f32_16x16x32_bf16 v[84:87], a[228:231], v[220:223], v[84:87]
tbuffer_load_format_d16_xyzw v[252:253], v6, s[16:19], s45 format:[BUF_DATA_FORMAT_32_32_32_32,BUF_NUM_FORMAT_UINT] offen
v_perm_b32 v226, v53, v52, s57
v_perm_b32 v227, v53, v52, s58
s_waitcnt lgkmcnt(4)
v_mfma_f32_16x16x32_bf16 a[176:179], a[232:235], v[208:211], a[176:179]
ds_write_b128 v18, v[224:227] offset:16384
v_perm_b32 v50, v29, v28, v41
v_perm_b32 v51, v31, v30, v41
v_mfma_f32_16x16x32_bf16 a[180:183], a[232:235], v[212:215], a[180:183]
v_perm_b32 v228, v51, v50, s57
v_perm_b32 v229, v51, v50, s58
v_mfma_f32_16x16x32_bf16 a[184:187], a[232:235], v[216:219], a[184:187]
tbuffer_load_format_d16_xyzw v[254:255], v7, s[16:19], s45 format:[BUF_DATA_FORMAT_32_32_32_32,BUF_NUM_FORMAT_UINT] offen
v_perm_b32 v52, v29, v28, v43
v_perm_b32 v53, v31, v30, v43
v_mfma_f32_16x16x32_bf16 a[188:191], a[232:235], v[220:223], a[188:191]
v_perm_b32 v230, v53, v52, s57
v_perm_b32 v231, v53, v52, s58
v_mfma_f32_16x16x32_bf16 a[192:195], a[236:239], v[208:211], a[192:195]
s_add_u32 m0, s55, 110592
ds_write_b128 v18, v[228:231] offset:17408
v_perm_b32 v50, v33, v32, v54
v_perm_b32 v51, v35, v34, v54
v_mfma_f32_16x16x32_bf16 a[196:199], a[236:239], v[212:215], a[196:199]
buffer_load_dwordx4 v8, s[12:15], s36 offen  lds
v_perm_b32 v232, v51, v50, s57
v_perm_b32 v233, v51, v50, s58
v_mfma_f32_16x16x32_bf16 a[200:203], a[236:239], v[216:219], a[200:203]
v_perm_b32 v52, v33, v32, v55
v_perm_b32 v53, v35, v34, v55
v_mfma_f32_16x16x32_bf16 a[204:207], a[236:239], v[220:223], a[204:207]
v_perm_b32 v234, v53, v52, s57
v_perm_b32 v235, v53, v52, s58
s_waitcnt lgkmcnt(4)
v_mfma_f32_16x16x32_bf16 v[56:59], a[240:243], a[96:99], v[56:59]
buffer_load_dwordx4 v9, s[12:15], s36 offen offset:1024  lds
ds_write_b128 v18, v[232:235] offset:18432
v_perm_b32 v50, v37, v36, v45
v_perm_b32 v51, v39, v38, v45
v_mfma_f32_16x16x32_bf16 v[60:63], a[240:243], a[100:103], v[60:63]
v_perm_b32 v236, v51, v50, s57
v_perm_b32 v237, v51, v50, s58
v_mfma_f32_16x16x32_bf16 v[64:67], a[240:243], a[104:107], v[64:67]
v_perm_b32 v52, v37, v36, v47
v_perm_b32 v53, v39, v38, v47
v_mfma_f32_16x16x32_bf16 v[68:71], a[240:243], a[108:111], v[68:71]
buffer_load_dwordx4 v10, s[12:15], s36 offen offset:2048  lds
v_perm_b32 v238, v53, v52, s57
v_perm_b32 v239, v53, v52, s58
v_mfma_f32_16x16x32_bf16 v[72:75], a[244:247], a[96:99], v[72:75]
ds_write_b128 v18, v[236:239] offset:19456
v_mfma_f32_16x16x32_bf16 v[76:79], a[244:247], a[100:103], v[76:79]
v_mfma_f32_16x16x32_bf16 v[80:83], a[244:247], a[104:107], v[80:83]
v_mfma_f32_16x16x32_bf16 v[84:87], a[244:247], a[108:111], v[84:87]
buffer_load_dwordx4 v11, s[12:15], s36 offen offset:3072  lds
s_waitcnt vmcnt(12) lgkmcnt(0)
s_barrier
ds_read_b128 a[224:227], v14 offset:18432
ds_read_b128 a[228:231], v14 offset:20480
ds_read_b128 a[112:115], v19 offset:16384
ds_read_b128 a[116:119], v19 offset:17408
ds_read_b128 a[120:123], v19 offset:18432
ds_read_b128 a[124:127], v19 offset:19456
ds_read_b128 a[232:235], v14 offset:22528
ds_read_b128 a[236:239], v14 offset:24576
ds_read_b128 a[240:243], v15 offset:18432
ds_read_b128 a[244:247], v15 offset:20480
v_mfma_f32_16x16x32_bf16 a[176:179], a[248:251], a[96:99], a[176:179]
v_mfma_f32_16x16x32_bf16 a[180:183], a[248:251], a[100:103], a[180:183]
v_mfma_f32_16x16x32_bf16 a[184:187], a[248:251], a[104:107], a[184:187]
v_mfma_f32_16x16x32_bf16 a[188:191], a[248:251], a[108:111], a[188:191]
ds_read_b128 a[248:251], v15 offset:22528
v_mfma_f32_16x16x32_bf16 a[192:195], a[252:255], a[96:99], a[192:195]
s_waitcnt vmcnt(4)
v_lshl_or_b32 v40, v242, 8, v240
v_lshl_or_b32 v41, v246, 8, v244
v_mfma_f32_16x16x32_bf16 a[196:199], a[252:255], a[100:103], a[196:199]
v_lshl_or_b32 v42, v250, 8, v248
v_lshl_or_b32 v43, v254, 8, v252
v_mfma_f32_16x16x32_bf16 a[200:203], a[252:255], a[104:107], a[200:203]
v_lshl_or_b32 v44, v243, 8, v241
v_lshl_or_b32 v45, v247, 8, v245
v_mfma_f32_16x16x32_bf16 a[204:207], a[252:255], a[108:111], a[204:207]
v_lshl_or_b32 v46, v251, 8, v249
v_lshl_or_b32 v47, v255, 8, v253
ds_read_b128 a[252:255], v15 offset:24576
s_waitcnt lgkmcnt(10)
v_mfma_f32_16x16x32_bf16 v[56:59], a[224:227], v[224:227], v[56:59]
v_perm_b32 v48, v41, v40, s59
v_perm_b32 v41, v41, v40, s60
v_mfma_f32_16x16x32_bf16 v[60:63], a[224:227], v[228:231], v[60:63]
v_perm_b32 v49, v43, v42, s59
v_perm_b32 v43, v43, v42, s60
v_mfma_f32_16x16x32_bf16 v[64:67], a[224:227], v[232:235], v[64:67]
v_perm_b32 v54, v45, v44, s59
v_perm_b32 v45, v45, v44, s60
v_mfma_f32_16x16x32_bf16 v[68:71], a[224:227], v[236:239], v[68:71]
v_perm_b32 v55, v47, v46, s59
v_perm_b32 v47, v47, v46, s60
v_mfma_f32_16x16x32_bf16 v[72:75], a[228:231], v[224:227], v[72:75]
v_perm_b32 v50, v25, v24, v48
v_perm_b32 v51, v27, v26, v48
v_mfma_f32_16x16x32_bf16 v[76:79], a[228:231], v[228:231], v[76:79]
s_add_u32 m0, s56, 0
v_perm_b32 v240, v51, v50, s57
v_perm_b32 v241, v51, v50, s58
v_mfma_f32_16x16x32_bf16 v[80:83], a[228:231], v[232:235], v[80:83]
buffer_load_dwordx4 v13, s[12:15], s46 offen  lds
v_perm_b32 v52, v25, v24, v49
v_perm_b32 v53, v27, v26, v49
v_mfma_f32_16x16x32_bf16 v[84:87], a[228:231], v[236:239], v[84:87]
v_perm_b32 v242, v53, v52, s57
v_perm_b32 v243, v53, v52, s58
s_waitcnt lgkmcnt(4)
v_mfma_f32_16x16x32_bf16 a[176:179], a[232:235], v[224:227], a[176:179]
ds_write_b128 v18, v[240:243] offset:0
v_perm_b32 v50, v29, v28, v41
v_perm_b32 v51, v31, v30, v41
v_mfma_f32_16x16x32_bf16 a[180:183], a[232:235], v[228:231], a[180:183]
v_perm_b32 v244, v51, v50, s57
v_perm_b32 v245, v51, v50, s58
v_mfma_f32_16x16x32_bf16 a[184:187], a[232:235], v[232:235], a[184:187]
buffer_load_dwordx4 v13, s[12:15], s47 offen offset:2048  lds
v_perm_b32 v52, v29, v28, v43
v_perm_b32 v53, v31, v30, v43
v_mfma_f32_16x16x32_bf16 a[188:191], a[232:235], v[236:239], a[188:191]
v_perm_b32 v246, v53, v52, s57
v_perm_b32 v247, v53, v52, s58
v_mfma_f32_16x16x32_bf16 a[192:195], a[236:239], v[224:227], a[192:195]
ds_write_b128 v18, v[244:247] offset:1024
v_perm_b32 v50, v33, v32, v54
v_perm_b32 v51, v35, v34, v54
v_mfma_f32_16x16x32_bf16 a[196:199], a[236:239], v[228:231], a[196:199]
s_add_u32 m0, s56, 4096
v_perm_b32 v248, v51, v50, s57
v_perm_b32 v249, v51, v50, s58
v_mfma_f32_16x16x32_bf16 a[200:203], a[236:239], v[232:235], a[200:203]
buffer_load_dwordx4 v13, s[12:15], s48 offen  lds
v_perm_b32 v52, v33, v32, v55
v_perm_b32 v53, v35, v34, v55
v_mfma_f32_16x16x32_bf16 a[204:207], a[236:239], v[236:239], a[204:207]
v_perm_b32 v250, v53, v52, s57
v_perm_b32 v251, v53, v52, s58
s_waitcnt lgkmcnt(4)
v_mfma_f32_16x16x32_bf16 v[56:59], a[240:243], a[112:115], v[56:59]
ds_write_b128 v18, v[248:251] offset:2048
v_perm_b32 v50, v37, v36, v45
v_perm_b32 v51, v39, v38, v45
v_mfma_f32_16x16x32_bf16 v[60:63], a[240:243], a[116:119], v[60:63]
v_perm_b32 v252, v51, v50, s57
v_perm_b32 v253, v51, v50, s58
v_mfma_f32_16x16x32_bf16 v[64:67], a[240:243], a[120:123], v[64:67]
buffer_load_dwordx4 v13, s[12:15], s49 offen offset:2048  lds
v_perm_b32 v52, v37, v36, v47
v_perm_b32 v53, v39, v38, v47
v_mfma_f32_16x16x32_bf16 v[68:71], a[240:243], a[124:127], v[68:71]
v_perm_b32 v254, v53, v52, s57
v_perm_b32 v255, v53, v52, s58
v_mfma_f32_16x16x32_bf16 v[72:75], a[244:247], a[112:115], v[72:75]
ds_write_b128 v18, v[252:255] offset:3072
v_mfma_f32_16x16x32_bf16 v[76:79], a[244:247], a[116:119], v[76:79]
v_mfma_f32_16x16x32_bf16 v[80:83], a[244:247], a[120:123], v[80:83]
s_add_u32 m0, s56, 8192
v_mfma_f32_16x16x32_bf16 v[84:87], a[244:247], a[124:127], v[84:87]
buffer_load_dwordx4 v13, s[12:15], s50 offen  lds
s_waitcnt vmcnt(5) lgkmcnt(0)
s_barrier
ds_read_b128 a[224:227], v14 offset:36864
ds_read_b128 a[228:231], v14 offset:38912
ds_read_b128 a[128:131], v19 offset:0
ds_read_b128 a[132:135], v19 offset:1024
ds_read_b128 a[136:139], v19 offset:2048
ds_read_b128 a[140:143], v19 offset:3072
ds_read_b128 a[232:235], v14 offset:40960
ds_read_b128 a[236:239], v14 offset:43008
ds_read_b128 a[240:243], v15 offset:36864
ds_read_b128 a[244:247], v15 offset:38912
v_mfma_f32_16x16x32_bf16 a[176:179], a[248:251], a[112:115], a[176:179]
v_mfma_f32_16x16x32_bf16 a[180:183], a[248:251], a[116:119], a[180:183]
buffer_load_dwordx4 v13, s[12:15], s51 offen offset:2048  lds
v_mfma_f32_16x16x32_bf16 a[184:187], a[248:251], a[120:123], a[184:187]
s_add_u32 m0, s56, 12288
v_mfma_f32_16x16x32_bf16 a[188:191], a[248:251], a[124:127], a[188:191]
buffer_load_dwordx4 v13, s[12:15], s52 offen  lds
ds_read_b128 a[248:251], v15 offset:40960
v_mfma_f32_16x16x32_bf16 a[192:195], a[252:255], a[112:115], a[192:195]
v_mfma_f32_16x16x32_bf16 a[196:199], a[252:255], a[116:119], a[196:199]
buffer_load_dwordx4 v13, s[12:15], s53 offen offset:2048  lds
v_mfma_f32_16x16x32_bf16 a[200:203], a[252:255], a[120:123], a[200:203]
v_mfma_f32_16x16x32_bf16 a[204:207], a[252:255], a[124:127], a[204:207]
s_add_u32 m0, s56, 16384
ds_read_b128 a[252:255], v15 offset:43008
s_waitcnt lgkmcnt(10)
v_mfma_f32_16x16x32_bf16 v[56:59], a[224:227], v[240:243], v[56:59]
buffer_load_dwordx4 v13, s[12:15], s54 offen  lds
v_mfma_f32_16x16x32_bf16 v[60:63], a[224:227], v[244:247], v[60:63]
v_mfma_f32_16x16x32_bf16 v[64:67], a[224:227], v[248:251], v[64:67]
v_mfma_f32_16x16x32_bf16 v[68:71], a[224:227], v[252:255], v[68:71]
v_add_u32 v13, s5, v13
s_add_u32 m0, s56, 36864
v_mfma_f32_16x16x32_bf16 v[72:75], a[228:231], v[240:243], v[72:75]
buffer_load_dwordx4 v13, s[12:15], s46 offen  lds
v_mfma_f32_16x16x32_bf16 v[76:79], a[228:231], v[244:247], v[76:79]
v_mfma_f32_16x16x32_bf16 v[80:83], a[228:231], v[248:251], v[80:83]
v_mfma_f32_16x16x32_bf16 v[84:87], a[228:231], v[252:255], v[84:87]
s_waitcnt lgkmcnt(4)
v_mfma_f32_16x16x32_bf16 a[176:179], a[232:235], v[240:243], a[176:179]
buffer_load_dwordx4 v13, s[12:15], s47 offen offset:2048  lds
v_mfma_f32_16x16x32_bf16 a[180:183], a[232:235], v[244:247], a[180:183]
v_mfma_f32_16x16x32_bf16 a[184:187], a[232:235], v[248:251], a[184:187]
v_mfma_f32_16x16x32_bf16 a[188:191], a[232:235], v[252:255], a[188:191]
v_mfma_f32_16x16x32_bf16 a[192:195], a[236:239], v[240:243], a[192:195]
s_add_u32 m0, s56, 40960
v_mfma_f32_16x16x32_bf16 a[196:199], a[236:239], v[244:247], a[196:199]
buffer_load_dwordx4 v13, s[12:15], s48 offen  lds
v_mfma_f32_16x16x32_bf16 a[200:203], a[236:239], v[248:251], a[200:203]
v_mfma_f32_16x16x32_bf16 a[204:207], a[236:239], v[252:255], a[204:207]
s_mul_i32 s23, s61, 10240
s_waitcnt lgkmcnt(2)
v_mfma_f32_16x16x32_bf16 v[56:59], a[240:243], a[128:131], v[56:59]
v_mfma_f32_16x16x32_bf16 v[60:63], a[240:243], a[132:135], v[60:63]
buffer_load_dwordx4 v13, s[12:15], s49 offen offset:2048  lds
v_mfma_f32_16x16x32_bf16 v[64:67], a[240:243], a[136:139], v[64:67]
v_mfma_f32_16x16x32_bf16 v[68:71], a[240:243], a[140:143], v[68:71]
v_mfma_f32_16x16x32_bf16 v[72:75], a[244:247], a[128:131], v[72:75]
v_mfma_f32_16x16x32_bf16 v[76:79], a[244:247], a[132:135], v[76:79]
s_add_u32 m0, s56, 45056
v_mfma_f32_16x16x32_bf16 v[80:83], a[244:247], a[136:139], v[80:83]
buffer_load_dwordx4 v13, s[12:15], s50 offen  lds
v_mfma_f32_16x16x32_bf16 v[84:87], a[244:247], a[140:143], v[84:87]
s_waitcnt vmcnt(9) lgkmcnt(0)
s_barrier
ds_read_b128 a[224:227], v16 offset:0
ds_read_b128 a[228:231], v17 offset:0
ds_read_b128 a[232:235], v16 offset:2048
ds_read_b128 a[236:239], v17 offset:2048
v_add_u32 v14, s23, v14
v_add_u32 v15, s23, v15
v_mfma_f32_16x16x32_bf16 a[176:179], a[248:251], a[128:131], a[176:179]
v_mfma_f32_16x16x32_bf16 a[180:183], a[248:251], a[132:135], a[180:183]
v_mfma_f32_16x16x32_bf16 a[184:187], a[248:251], a[136:139], a[184:187]
v_mfma_f32_16x16x32_bf16 a[188:191], a[248:251], a[140:143], a[188:191]
v_mfma_f32_16x16x32_bf16 a[192:195], a[252:255], a[128:131], a[192:195]
v_mfma_f32_16x16x32_bf16 a[196:199], a[252:255], a[132:135], a[196:199]
v_mfma_f32_16x16x32_bf16 a[200:203], a[252:255], a[136:139], a[200:203]
L_page_2:
s_cbranch_execz L_hopback
v_mfma_f32_16x16x32_bf16 a[204:207], a[252:255], a[140:143], a[204:207]
ds_read_b128 a[240:243], v16 offset:4096
s_waitcnt lgkmcnt(4)
v_mfma_f32_16x16x32_bf16 v[24:27], a[224:227], v[112:115], 0
v_mfma_f32_16x16x32_bf16 v[28:31], a[224:227], v[116:119], 0
v_mfma_f32_16x16x32_bf16 v[32:35], a[224:227], v[120:123], 0
buffer_load_dwordx4 v13, s[12:15], s51 offen offset:2048  lds
v_mfma_f32_16x16x32_bf16 v[36:39], a[224:227], v[124:127], 0
ds_read_b128 a[244:247], v17 offset:4096
s_waitcnt lgkmcnt(4)
v_mfma_f32_16x16x32_bf16 v[24:27], a[228:231], a[0:3], v[24:27]
s_add_u32 s22, s21, 0
v_cvt_pk_bf16_f32 v88, v56, v60
v_mfma_f32_16x16x32_bf16 v[28:31], a[228:231], a[4:7], v[28:31]
v_cvt_pk_bf16_f32 v89, v64, v68
buffer_store_dwordx2 v[88:89], v20, s[24:27], s22 offen nt
v_mfma_f32_16x16x32_bf16 v[32:35], a[228:231], a[8:11], v[32:35]
v_mfma_f32_16x16x32_bf16 v[36:39], a[228:231], a[12:15], v[36:39]
ds_read_b128 a[248:251], v16 offset:6144
s_waitcnt lgkmcnt(4)
v_mfma_f32_16x16x32_bf16 v[24:27], a[232:235], v[128:131], v[24:27]
s_add_u32 m0, s56, 49152
v_mfma_f32_16x16x32_bf16 v[28:31], a[232:235], v[132:135], v[28:31]
buffer_load_dwordx4 v13, s[12:15], s52 offen  lds
v_mfma_f32_16x16x32_bf16 v[32:35], a[232:235], v[136:139], v[32:35]
v_mfma_f32_16x16x32_bf16 v[36:39], a[232:235], v[140:143], v[36:39]
ds_read_b128 a[252:255], v17 offset:6144
s_waitcnt lgkmcnt(4)
v_mfma_f32_16x16x32_bf16 v[24:27], a[236:239], a[16:19], v[24:27]
v_mfma_f32_16x16x32_bf16 v[28:31], a[236:239], a[20:23], v[28:31]
v_mfma_f32_16x16x32_bf16 v[32:35], a[236:239], a[24:27], v[32:35]
buffer_load_dwordx4 v13, s[12:15], s53 offen offset:2048  lds
v_mfma_f32_16x16x32_bf16 v[36:39], a[236:239], a[28:31], v[36:39]
ds_read_b128 a[224:227], v16 offset:8192
s_waitcnt lgkmcnt(4)
v_mfma_f32_16x16x32_bf16 v[24:27], a[240:243], v[144:147], v[24:27]
v_mfma_f32_16x16x32_bf16 v[28:31], a[240:243], v[148:151], v[28:31]
v_mfma_f32_16x16x32_bf16 v[32:35], a[240:243], v[152:155], v[32:35]
v_mfma_f32_16x16x32_bf16 v[36:39], a[240:243], v[156:159], v[36:39]
ds_read_b128 a[228:231], v17 offset:8192
s_waitcnt lgkmcnt(4)
v_mfma_f32_16x16x32_bf16 v[24:27], a[244:247], a[32:35], v[24:27]
s_add_u32 m0, s56, 53248
v_cvt_pk_bf16_f32 v90, v57, v61
v_mfma_f32_16x16x32_bf16 v[28:31], a[244:247], a[36:39], v[28:31]
buffer_load_dwordx4 v13, s[12:15], s54 offen  lds
v_cvt_pk_bf16_f32 v91, v65, v69
v_mfma_f32_16x16x32_bf16 v[32:35], a[244:247], a[40:43], v[32:35]
buffer_store_dwordx2 v[90:91], v21, s[24:27], s22 offen nt
v_mfma_f32_16x16x32_bf16 v[36:39], a[244:247], a[44:47], v[36:39]
s_waitcnt vmcnt(11)
s_barrier
ds_read_b128 a[232:235], v16 offset:10240
s_waitcnt lgkmcnt(4)
v_mfma_f32_16x16x32_bf16 v[24:27], a[248:251], v[160:163], v[24:27]
v_mfma_f32_16x16x32_bf16 v[28:31], a[248:251], v[164:167], v[28:31]
v_mfma_f32_16x16x32_bf16 v[32:35], a[248:251], v[168:171], v[32:35]
v_mfma_f32_16x16x32_bf16 v[36:39], a[248:251], v[172:175], v[36:39]
ds_read_b128 a[236:239], v17 offset:10240
s_waitcnt lgkmcnt(4)
v_mfma_f32_16x16x32_bf16 v[24:27], a[252:255], a[48:51], v[24:27]
v_mfma_f32_16x16x32_bf16 v[28:31], a[252:255], a[52:55], v[28:31]
v_mfma_f32_16x16x32_bf16 v[32:35], a[252:255], a[56:59], v[32:35]
v_mfma_f32_16x16x32_bf16 v[36:39], a[252:255], a[60:63], v[36:39]
ds_read_b128 a[240:243], v16 offset:12288
s_waitcnt lgkmcnt(4)
v_mfma_f32_16x16x32_bf16 v[24:27], a[224:227], v[176:179], v[24:27]
v_mfma_f32_16x16x32_bf16 v[28:31], a[224:227], v[180:183], v[28:31]
v_add_u32 v13, s6, v13
s_add_u32 m0, s56, 73728
v_mfma_f32_16x16x32_bf16 v[32:35], a[224:227], v[184:187], v[32:35]
buffer_load_dwordx4 v13, s[12:15], s46 offen  lds
v_mfma_f32_16x16x32_bf16 v[36:39], a[224:227], v[188:191], v[36:39]
ds_read_b128 a[244:247], v17 offset:12288
s_waitcnt lgkmcnt(4)
v_mfma_f32_16x16x32_bf16 v[24:27], a[228:231], a[64:67], v[24:27]
v_cvt_pk_bf16_f32 v92, v58, v62
v_cvt_pk_bf16_f32 v93, v66, v70
v_mfma_f32_16x16x32_bf16 v[28:31], a[228:231], a[68:71], v[28:31]
buffer_store_dwordx2 v[92:93], v22, s[24:27], s22 offen nt
v_mfma_f32_16x16x32_bf16 v[32:35], a[228:231], a[72:75], v[32:35]
v_mfma_f32_16x16x32_bf16 v[36:39], a[228:231], a[76:79], v[36:39]
ds_read_b128 a[248:251], v16 offset:14336
s_waitcnt lgkmcnt(4)
v_mfma_f32_16x16x32_bf16 v[24:27], a[232:235], v[192:195], v[24:27]
v_mfma_f32_16x16x32_bf16 v[28:31], a[232:235], v[196:199], v[28:31]
v_mfma_f32_16x16x32_bf16 v[32:35], a[232:235], v[200:203], v[32:35]
v_mfma_f32_16x16x32_bf16 v[36:39], a[232:235], v[204:207], v[36:39]
ds_read_b128 a[252:255], v17 offset:14336
s_waitcnt lgkmcnt(4)
v_mfma_f32_16x16x32_bf16 v[24:27], a[236:239], a[80:83], v[24:27]
buffer_load_dwordx4 v13, s[12:15], s47 offen offset:2048  lds
v_mfma_f32_16x16x32_bf16 v[28:31], a[236:239], a[84:87], v[28:31]
v_mfma_f32_16x16x32_bf16 v[32:35], a[236:239], a[88:91], v[32:35]
v_mfma_f32_16x16x32_bf16 v[36:39], a[236:239], a[92:95], v[36:39]
ds_read_b128 a[224:227], v16 offset:16384
s_waitcnt lgkmcnt(4)
v_mfma_f32_16x16x32_bf16 v[24:27], a[240:243], v[208:211], v[24:27]
v_mfma_f32_16x16x32_bf16 v[28:31], a[240:243], v[212:215], v[28:31]
v_mfma_f32_16x16x32_bf16 v[32:35], a[240:243], v[216:219], v[32:35]
v_cvt_pk_bf16_f32 v94, v59, v63
v_cvt_pk_bf16_f32 v95, v67, v71
v_mfma_f32_16x16x32_bf16 v[36:39], a[240:243], v[220:223], v[36:39]
ds_read_b128 a[228:231], v17 offset:16384
s_waitcnt lgkmcnt(4)
v_mfma_f32_16x16x32_bf16 v[24:27], a[244:247], a[96:99], v[24:27]
s_add_u32 m0, s56, 77824
buffer_store_dwordx2 v[94:95], v23, s[24:27], s22 offen nt
v_mfma_f32_16x16x32_bf16 v[28:31], a[244:247], a[100:103], v[28:31]
buffer_load_dwordx4 v13, s[12:15], s48 offen  lds
v_mfma_f32_16x16x32_bf16 v[32:35], a[244:247], a[104:107], v[32:35]
v_mfma_f32_16x16x32_bf16 v[36:39], a[244:247], a[108:111], v[36:39]
s_waitcnt lgkmcnt(3)
v_mfma_f32_16x16x32_bf16 v[24:27], a[248:251], v[224:227], v[24:27]
v_mfma_f32_16x16x32_bf16 v[28:31], a[248:251], v[228:231], v[28:31]
v_mfma_f32_16x16x32_bf16 v[32:35], a[248:251], v[232:235], v[32:35]
v_mfma_f32_16x16x32_bf16 v[36:39], a[248:251], v[236:239], v[36:39]
s_waitcnt vmcnt(6) lgkmcnt(0)
s_barrier
ds_read_b128 a[232:235], v16 offset:36864
ds_read_b128 a[236:239], v17 offset:36864
v_mfma_f32_16x16x32_bf16 v[24:27], a[252:255], a[112:115], v[24:27]
v_mfma_f32_16x16x32_bf16 v[28:31], a[252:255], a[116:119], v[28:31]
buffer_load_dwordx4 v13, s[12:15], s49 offen offset:2048  lds
v_mfma_f32_16x16x32_bf16 v[32:35], a[252:255], a[120:123], v[32:35]
v_mfma_f32_16x16x32_bf16 v[36:39], a[252:255], a[124:127], v[36:39]
ds_read_b128 a[240:243], v16 offset:38912
v_mfma_f32_16x16x32_bf16 v[24:27], a[224:227], v[240:243], v[24:27]
v_mfma_f32_16x16x32_bf16 v[28:31], a[224:227], v[244:247], v[28:31]
v_mfma_f32_16x16x32_bf16 v[32:35], a[224:227], v[248:251], v[32:35]
v_mfma_f32_16x16x32_bf16 v[36:39], a[224:227], v[252:255], v[36:39]
ds_read_b128 a[244:247], v17 offset:38912
v_mfma_f32_16x16x32_bf16 v[40:43], a[228:231], a[128:131], v[24:27]
v_mfma_f32_16x16x32_bf16 v[44:47], a[228:231], a[132:135], v[28:31]
s_add_u32 m0, s56, 81920
v_mfma_f32_16x16x32_bf16 v[48:51], a[228:231], a[136:139], v[32:35]
buffer_load_dwordx4 v13, s[12:15], s50 offen  lds
v_mfma_f32_16x16x32_bf16 v[52:55], a[228:231], a[140:143], v[36:39]
ds_read_b128 a[248:251], v16 offset:40960
s_waitcnt lgkmcnt(4)
v_mfma_f32_16x16x32_bf16 v[24:27], a[232:235], v[112:115], 0
v_mfma_f32_16x16x32_bf16 v[28:31], a[232:235], v[116:119], 0
v_mfma_f32_16x16x32_bf16 v[32:35], a[232:235], v[120:123], 0
buffer_load_dwordx4 v13, s[12:15], s51 offen offset:2048  lds
v_mfma_f32_16x16x32_bf16 v[36:39], a[232:235], v[124:127], 0
ds_read_b128 a[252:255], v17 offset:40960
s_waitcnt lgkmcnt(4)
v_mfma_f32_16x16x32_bf16 v[24:27], a[236:239], a[0:3], v[24:27]
v_cvt_pk_bf16_f32 v88, v40, v44
v_cvt_pk_bf16_f32 v89, v48, v52
v_mfma_f32_16x16x32_bf16 v[28:31], a[236:239], a[4:7], v[28:31]
buffer_store_dwordx2 v[88:89], v20, s[24:27], s96 offen nt
v_mfma_f32_16x16x32_bf16 v[32:35], a[236:239], a[8:11], v[32:35]
v_mfma_f32_16x16x32_bf16 v[36:39], a[236:239], a[12:15], v[36:39]
ds_read_b128 a[224:227], v16 offset:43008
s_waitcnt lgkmcnt(4)
v_mfma_f32_16x16x32_bf16 v[24:27], a[240:243], v[128:131], v[24:27]
s_add_u32 m0, s56, 86016
v_mfma_f32_16x16x32_bf16 v[28:31], a[240:243], v[132:135], v[28:31]
buffer_load_dwordx4 v13, s[12:15], s52 offen  lds
v_mfma_f32_16x16x32_bf16 v[32:35], a[240:243], v[136:139], v[32:35]
v_mfma_f32_16x16x32_bf16 v[36:39], a[240:243], v[140:143], v[36:39]
ds_read_b128 a[228:231], v17 offset:43008
s_waitcnt lgkmcnt(4)
v_mfma_f32_16x16x32_bf16 v[24:27], a[244:247], a[16:19], v[24:27]
v_cvt_pk_bf16_f32 v90, v41, v45
v_cvt_pk_bf16_f32 v91, v49, v53
v_mfma_f32_16x16x32_bf16 v[28:31], a[244:247], a[20:23], v[28:31]
buffer_store_dwordx2 v[90:91], v21, s[24:27], s96 offen nt
v_mfma_f32_16x16x32_bf16 v[32:35], a[244:247], a[24:27], v[32:35]
v_mfma_f32_16x16x32_bf16 v[36:39], a[244:247], a[28:31], v[36:39]
ds_read_b128 a[232:235], v16 offset:45056
s_waitcnt lgkmcnt(4)
v_mfma_f32_16x16x32_bf16 v[24:27], a[248:251], v[144:147], v[24:27]
buffer_load_dwordx4 v13, s[12:15], s53 offen offset:2048  lds
v_mfma_f32_16x16x32_bf16 v[28:31], a[248:251], v[148:151], v[28:31]
v_mfma_f32_16x16x32_bf16 v[32:35], a[248:251], v[152:155], v[32:35]
v_mfma_f32_16x16x32_bf16 v[36:39], a[248:251], v[156:159], v[36:39]
ds_read_b128 a[236:239], v17 offset:45056
s_waitcnt lgkmcnt(4)
v_mfma_f32_16x16x32_bf16 v[24:27], a[252:255], a[32:35], v[24:27]
v_cvt_pk_bf16_f32 v92, v42, v46
v_cvt_pk_bf16_f32 v93, v50, v54
v_mfma_f32_16x16x32_bf16 v[28:31], a[252:255], a[36:39], v[28:31]
buffer_store_dwordx2 v[92:93], v22, s[24:27], s96 offen nt
v_mfma_f32_16x16x32_bf16 v[32:35], a[252:255], a[40:43], v[32:35]
v_mfma_f32_16x16x32_bf16 v[36:39], a[252:255], a[44:47], v[36:39]
ds_read_b128 a[240:243], v16 offset:47104
s_waitcnt lgkmcnt(4)
v_mfma_f32_16x16x32_bf16 v[24:27], a[224:227], v[160:163], v[24:27]
s_add_u32 m0, s56, 90112
v_mfma_f32_16x16x32_bf16 v[28:31], a[224:227], v[164:167], v[28:31]
buffer_load_dwordx4 v13, s[12:15], s54 offen  lds
v_mfma_f32_16x16x32_bf16 v[32:35], a[224:227], v[168:171], v[32:35]
v_mfma_f32_16x16x32_bf16 v[36:39], a[224:227], v[172:175], v[36:39]
ds_read_b128 a[244:247], v17 offset:47104
s_waitcnt lgkmcnt(4)
v_mfma_f32_16x16x32_bf16 v[24:27], a[228:231], a[48:51], v[24:27]
v_cvt_pk_bf16_f32 v94, v43, v47
v_cvt_pk_bf16_f32 v95, v51, v55
v_mfma_f32_16x16x32_bf16 v[28:31], a[228:231], a[52:55], v[28:31]
buffer_store_dwordx2 v[94:95], v23, s[24:27], s96 offen nt
v_mfma_f32_16x16x32_bf16 v[32:35], a[228:231], a[56:59], v[32:35]
v_mfma_f32_16x16x32_bf16 v[36:39], a[228:231], a[60:63], v[36:39]
ds_read_b128 a[248:251], v16 offset:49152
s_waitcnt lgkmcnt(4)
v_mfma_f32_16x16x32_bf16 v[24:27], a[232:235], v[176:179], v[24:27]
v_add_u32 v13, s7, v13
s_add_u32 m0, s56, 0
v_mfma_f32_16x16x32_bf16 v[28:31], a[232:235], v[180:183], v[28:31]
buffer_load_dwordx4 v13, s[12:15], s46 offen  lds
v_mfma_f32_16x16x32_bf16 v[32:35], a[232:235], v[184:187], v[32:35]
v_mfma_f32_16x16x32_bf16 v[36:39], a[232:235], v[188:191], v[36:39]
ds_read_b128 a[252:255], v17 offset:49152
s_waitcnt lgkmcnt(4)
v_mfma_f32_16x16x32_bf16 v[24:27], a[236:239], a[64:67], v[24:27]
s_add_u32 s22, s21, 147456
v_cvt_pk_bf16_f32 v88, v72, v76
v_mfma_f32_16x16x32_bf16 v[28:31], a[236:239], a[68:71], v[28:31]
v_cvt_pk_bf16_f32 v89, v80, v84
buffer_store_dwordx2 v[88:89], v20, s[24:27], s22 offen nt
v_mfma_f32_16x16x32_bf16 v[32:35], a[236:239], a[72:75], v[32:35]
v_mfma_f32_16x16x32_bf16 v[36:39], a[236:239], a[76:79], v[36:39]
ds_read_b128 a[224:227], v16 offset:51200
s_waitcnt lgkmcnt(4)
v_mfma_f32_16x16x32_bf16 v[24:27], a[240:243], v[192:195], v[24:27]
v_mfma_f32_16x16x32_bf16 v[28:31], a[240:243], v[196:199], v[28:31]
buffer_load_dwordx4 v13, s[12:15], s47 offen offset:2048  lds
v_mfma_f32_16x16x32_bf16 v[32:35], a[240:243], v[200:203], v[32:35]
v_cvt_pk_bf16_f32 v90, v73, v77
v_cvt_pk_bf16_f32 v91, v81, v85
v_mfma_f32_16x16x32_bf16 v[36:39], a[240:243], v[204:207], v[36:39]
ds_read_b128 a[228:231], v17 offset:51200
s_waitcnt lgkmcnt(4)
v_mfma_f32_16x16x32_bf16 v[24:27], a[244:247], a[80:83], v[24:27]
buffer_store_dwordx2 v[90:91], v21, s[24:27], s22 offen nt
v_mfma_f32_16x16x32_bf16 v[28:31], a[244:247], a[84:87], v[28:31]
v_mfma_f32_16x16x32_bf16 v[32:35], a[244:247], a[88:91], v[32:35]
v_mfma_f32_16x16x32_bf16 v[36:39], a[244:247], a[92:95], v[36:39]
ds_read_b128 a[232:235], v16 offset:53248
s_waitcnt lgkmcnt(4)
v_mfma_f32_16x16x32_bf16 v[24:27], a[248:251], v[208:211], v[24:27]
v_mfma_f32_16x16x32_bf16 v[28:31], a[248:251], v[212:215], v[28:31]
v_mfma_f32_16x16x32_bf16 v[32:35], a[248:251], v[216:219], v[32:35]
s_add_u32 m0, s56, 4096
v_cvt_pk_bf16_f32 v92, v74, v78
v_mfma_f32_16x16x32_bf16 v[36:39], a[248:251], v[220:223], v[36:39]
ds_read_b128 a[236:239], v17 offset:53248
s_waitcnt lgkmcnt(4)
v_mfma_f32_16x16x32_bf16 v[24:27], a[252:255], a[96:99], v[24:27]
buffer_load_dwordx4 v13, s[12:15], s48 offen  lds
v_cvt_pk_bf16_f32 v93, v82, v86
v_mfma_f32_16x16x32_bf16 v[28:31], a[252:255], a[100:103], v[28:31]
buffer_store_dwordx2 v[92:93], v22, s[24:27], s22 offen nt
v_mfma_f32_16x16x32_bf16 v[32:35], a[252:255], a[104:107], v[32:35]
v_mfma_f32_16x16x32_bf16 v[36:39], a[252:255], a[108:111], v[36:39]
s_waitcnt lgkmcnt(3)
v_mfma_f32_16x16x32_bf16 v[24:27], a[224:227], v[224:227], v[24:27]
v_mfma_f32_16x16x32_bf16 v[28:31], a[224:227], v[228:231], v[28:31]
v_mfma_f32_16x16x32_bf16 v[32:35], a[224:227], v[232:235], v[32:35]
v_cvt_pk_bf16_f32 v94, v75, v79
v_cvt_pk_bf16_f32 v95, v83, v87
v_mfma_f32_16x16x32_bf16 v[36:39], a[224:227], v[236:239], v[36:39]
s_waitcnt vmcnt(7) lgkmcnt(0)
s_barrier
ds_read_b128 a[240:243], v14 offset:0
ds_read_b128 a[244:247], v15 offset:0
v_mfma_f32_16x16x32_bf16 v[24:27], a[228:231], a[112:115], v[24:27]
buffer_load_dwordx4 v13, s[12:15], s49 offen offset:2048  lds
buffer_store_dwordx2 v[94:95], v23, s[24:27], s22 offen nt
v_mfma_f32_16x16x32_bf16 v[28:31], a[228:231], a[116:119], v[28:31]
v_mfma_f32_16x16x32_bf16 v[32:35], a[228:231], a[120:123], v[32:35]
v_mfma_f32_16x16x32_bf16 v[36:39], a[228:231], a[124:127], v[36:39]
ds_read_b128 a[248:251], v14 offset:2048
v_mfma_f32_16x16x32_bf16 v[24:27], a[232:235], v[240:243], v[24:27]
v_mfma_f32_16x16x32_bf16 v[28:31], a[232:235], v[244:247], v[28:31]
v_mfma_f32_16x16x32_bf16 v[32:35], a[232:235], v[248:251], v[32:35]
v_mfma_f32_16x16x32_bf16 v[36:39], a[232:235], v[252:255], v[36:39]
ds_read_b128 a[252:255], v15 offset:2048
v_mfma_f32_16x16x32_bf16 v[40:43], a[236:239], a[128:131], v[24:27]
v_mfma_f32_16x16x32_bf16 v[44:47], a[236:239], a[132:135], v[28:31]
s_add_u32 m0, s56, 8192
v_mfma_f32_16x16x32_bf16 v[48:51], a[236:239], a[136:139], v[32:35]
buffer_load_dwordx4 v13, s[12:15], s50 offen  lds
v_mfma_f32_16x16x32_bf16 v[52:55], a[236:239], a[140:143], v[36:39]
ds_read_b128 a[224:227], v14 offset:4096
s_waitcnt lgkmcnt(4)
v_mfma_f32_16x16x32_bf16 v[24:27], a[240:243], v[112:115], 0
v_mfma_f32_16x16x32_bf16 v[28:31], a[240:243], v[116:119], 0
v_mfma_f32_16x16x32_bf16 v[32:35], a[240:243], v[120:123], 0
buffer_load_dwordx4 v13, s[12:15], s51 offen offset:2048  lds
v_mfma_f32_16x16x32_bf16 v[36:39], a[240:243], v[124:127], 0
ds_read_b128 a[228:231], v15 offset:4096
s_waitcnt lgkmcnt(4)
v_mfma_f32_16x16x32_bf16 v[24:27], a[244:247], a[0:3], v[24:27]
v_cvt_pk_bf16_f32 v88, v40, v44
v_cvt_pk_bf16_f32 v89, v48, v52
v_mfma_f32_16x16x32_bf16 v[28:31], a[244:247], a[4:7], v[28:31]
buffer_store_dwordx2 v[88:89], v20, s[24:27], s97 offen nt
v_mfma_f32_16x16x32_bf16 v[32:35], a[244:247], a[8:11], v[32:35]
v_mfma_f32_16x16x32_bf16 v[36:39], a[244:247], a[12:15], v[36:39]
ds_read_b128 a[232:235], v14 offset:6144
s_waitcnt lgkmcnt(4)
v_mfma_f32_16x16x32_bf16 v[24:27], a[248:251], v[128:131], v[24:27]
s_add_u32 m0, s56, 12288
v_mfma_f32_16x16x32_bf16 v[28:31], a[248:251], v[132:135], v[28:31]
buffer_load_dwordx4 v13, s[12:15], s52 offen  lds
v_mfma_f32_16x16x32_bf16 v[32:35], a[248:251], v[136:139], v[32:35]
v_mfma_f32_16x16x32_bf16 v[36:39], a[248:251], v[140:143], v[36:39]
ds_read_b128 a[236:239], v15 offset:6144
s_waitcnt lgkmcnt(4)
v_mfma_f32_16x16x32_bf16 v[24:27], a[252:255], a[16:19], v[24:27]
v_cvt_pk_bf16_f32 v90, v41, v45
v_cvt_pk_bf16_f32 v91, v49, v53
v_mfma_f32_16x16x32_bf16 v[28:31], a[252:255], a[20:23], v[28:31]
buffer_store_dwordx2 v[90:91], v21, s[24:27], s97 offen nt
v_mfma_f32_16x16x32_bf16 v[32:35], a[252:255], a[24:27], v[32:35]
v_mfma_f32_16x16x32_bf16 v[36:39], a[252:255], a[28:31], v[36:39]
ds_read_b128 a[240:243], v14 offset:8192
s_waitcnt lgkmcnt(4)
v_mfma_f32_16x16x32_bf16 v[24:27], a[224:227], v[144:147], v[24:27]
buffer_load_dwordx4 v13, s[12:15], s53 offen offset:2048  lds
v_mfma_f32_16x16x32_bf16 v[28:31], a[224:227], v[148:151], v[28:31]
v_mfma_f32_16x16x32_bf16 v[32:35], a[224:227], v[152:155], v[32:35]
v_mfma_f32_16x16x32_bf16 v[36:39], a[224:227], v[156:159], v[36:39]
ds_read_b128 a[244:247], v15 offset:8192
s_waitcnt lgkmcnt(4)
v_mfma_f32_16x16x32_bf16 v[24:27], a[228:231], a[32:35], v[24:27]
v_cvt_pk_bf16_f32 v92, v42, v46
v_cvt_pk_bf16_f32 v93, v50, v54
v_mfma_f32_16x16x32_bf16 v[28:31], a[228:231], a[36:39], v[28:31]
buffer_store_dwordx2 v[92:93], v22, s[24:27], s97 offen nt
v_mfma_f32_16x16x32_bf16 v[32:35], a[228:231], a[40:43], v[32:35]
v_mfma_f32_16x16x32_bf16 v[36:39], a[228:231], a[44:47], v[36:39]
ds_read_b128 a[248:251], v14 offset:10240
s_waitcnt lgkmcnt(4)
v_mfma_f32_16x16x32_bf16 v[24:27], a[232:235], v[160:163], v[24:27]
s_add_u32 m0, s56, 16384
v_mfma_f32_16x16x32_bf16 v[28:31], a[232:235], v[164:167], v[28:31]
buffer_load_dwordx4 v13, s[12:15], s54 offen  lds
v_mfma_f32_16x16x32_bf16 v[32:35], a[232:235], v[168:171], v[32:35]
v_mfma_f32_16x16x32_bf16 v[36:39], a[232:235], v[172:175], v[36:39]
ds_read_b128 a[252:255], v15 offset:10240
s_waitcnt lgkmcnt(4)
v_mfma_f32_16x16x32_bf16 v[24:27], a[236:239], a[48:51], v[24:27]
v_cvt_pk_bf16_f32 v94, v43, v47
v_cvt_pk_bf16_f32 v95, v51, v55
v_mfma_f32_16x16x32_bf16 v[28:31], a[236:239], a[52:55], v[28:31]
buffer_store_dwordx2 v[94:95], v23, s[24:27], s97 offen nt
v_mfma_f32_16x16x32_bf16 v[32:35], a[236:239], a[56:59], v[32:35]
v_mfma_f32_16x16x32_bf16 v[36:39], a[236:239], a[60:63], v[36:39]
ds_read_b128 a[224:227], v14 offset:12288
s_waitcnt lgkmcnt(4)
v_mfma_f32_16x16x32_bf16 v[24:27], a[240:243], v[176:179], v[24:27]
v_add_u32 v13, s8, v13
s_add_u32 m0, s56, 36864
v_mfma_f32_16x16x32_bf16 v[28:31], a[240:243], v[180:183], v[28:31]
buffer_load_dwordx4 v13, s[12:15], s46 offen  lds
v_mfma_f32_16x16x32_bf16 v[32:35], a[240:243], v[184:187], v[32:35]
v_mfma_f32_16x16x32_bf16 v[36:39], a[240:243], v[188:191], v[36:39]
ds_read_b128 a[228:231], v15 offset:12288
s_waitcnt lgkmcnt(4)
v_mfma_f32_16x16x32_bf16 v[24:27], a[244:247], a[64:67], v[24:27]
s_add_u32 s22, s21, 294912
v_accvgpr_read_b32 v96, a176
v_mfma_f32_16x16x32_bf16 v[28:31], a[244:247], a[68:71], v[28:31]
v_accvgpr_read_b32 v97, a180
v_accvgpr_read_b32 v98, a184
v_mfma_f32_16x16x32_bf16 v[32:35], a[244:247], a[72:75], v[32:35]
v_accvgpr_read_b32 v99, a188
v_cvt_pk_bf16_f32 v88, v96, v97
v_mfma_f32_16x16x32_bf16 v[36:39], a[244:247], a[76:79], v[36:39]
ds_read_b128 a[232:235], v14 offset:14336
s_waitcnt lgkmcnt(4)
v_mfma_f32_16x16x32_bf16 v[24:27], a[248:251], v[192:195], v[24:27]
v_cvt_pk_bf16_f32 v89, v98, v99
buffer_store_dwordx2 v[88:89], v20, s[24:27], s22 offen nt
v_mfma_f32_16x16x32_bf16 v[28:31], a[248:251], v[196:199], v[28:31]
buffer_load_dwordx4 v13, s[12:15], s47 offen offset:2048  lds
v_mfma_f32_16x16x32_bf16 v[32:35], a[248:251], v[200:203], v[32:35]
v_accvgpr_read_b32 v100, a177
v_accvgpr_read_b32 v101, a181
v_mfma_f32_16x16x32_bf16 v[36:39], a[248:251], v[204:207], v[36:39]
ds_read_b128 a[236:239], v15 offset:14336
s_waitcnt lgkmcnt(4)
v_mfma_f32_16x16x32_bf16 v[24:27], a[252:255], a[80:83], v[24:27]
v_accvgpr_read_b32 v102, a185
v_accvgpr_read_b32 v103, a189
v_mfma_f32_16x16x32_bf16 v[28:31], a[252:255], a[84:87], v[28:31]
v_cvt_pk_bf16_f32 v90, v100, v101
v_cvt_pk_bf16_f32 v91, v102, v103
v_mfma_f32_16x16x32_bf16 v[32:35], a[252:255], a[88:91], v[32:35]
buffer_store_dwordx2 v[90:91], v21, s[24:27], s22 offen nt
v_mfma_f32_16x16x32_bf16 v[36:39], a[252:255], a[92:95], v[36:39]
ds_read_b128 a[240:243], v14 offset:16384
s_waitcnt lgkmcnt(4)
v_mfma_f32_16x16x32_bf16 v[24:27], a[224:227], v[208:211], v[24:27]
v_mfma_f32_16x16x32_bf16 v[28:31], a[224:227], v[212:215], v[28:31]
v_mfma_f32_16x16x32_bf16 v[32:35], a[224:227], v[216:219], v[32:35]
s_add_u32 m0, s56, 40960
v_accvgpr_read_b32 v96, a178
v_mfma_f32_16x16x32_bf16 v[36:39], a[224:227], v[220:223], v[36:39]
ds_read_b128 a[244:247], v15 offset:16384
s_waitcnt lgkmcnt(4)
v_mfma_f32_16x16x32_bf16 v[24:27], a[228:231], a[96:99], v[24:27]
buffer_load_dwordx4 v13, s[12:15], s48 offen  lds
v_accvgpr_read_b32 v97, a182
v_mfma_f32_16x16x32_bf16 v[28:31], a[228:231], a[100:103], v[28:31]
v_accvgpr_read_b32 v98, a186
v_accvgpr_read_b32 v99, a190
v_mfma_f32_16x16x32_bf16 v[32:35], a[228:231], a[104:107], v[32:35]
v_cvt_pk_bf16_f32 v92, v96, v97
v_cvt_pk_bf16_f32 v93, v98, v99
v_mfma_f32_16x16x32_bf16 v[36:39], a[228:231], a[108:111], v[36:39]
s_waitcnt lgkmcnt(3)
v_mfma_f32_16x16x32_bf16 v[24:27], a[232:235], v[224:227], v[24:27]
buffer_store_dwordx2 v[92:93], v22, s[24:27], s22 offen nt
v_mfma_f32_16x16x32_bf16 v[28:31], a[232:235], v[228:231], v[28:31]
v_mfma_f32_16x16x32_bf16 v[32:35], a[232:235], v[232:235], v[32:35]
v_accvgpr_read_b32 v100, a179
v_accvgpr_read_b32 v101, a183
v_mfma_f32_16x16x32_bf16 v[36:39], a[232:235], v[236:239], v[36:39]
s_waitcnt vmcnt(7) lgkmcnt(0)
s_barrier
ds_read_b128 a[248:251], v16 offset:0
ds_read_b128 a[252:255], v17 offset:0
v_mfma_f32_16x16x32_bf16 v[24:27], a[236:239], a[112:115], v[24:27]
buffer_load_dwordx4 v13, s[12:15], s49 offen offset:2048  lds
v_accvgpr_read_b32 v102, a187
v_mfma_f32_16x16x32_bf16 v[28:31], a[236:239], a[116:119], v[28:31]
v_accvgpr_read_b32 v103, a191
v_cvt_pk_bf16_f32 v94, v100, v101
v_mfma_f32_16x16x32_bf16 v[32:35], a[236:239], a[120:123], v[32:35]
v_cvt_pk_bf16_f32 v95, v102, v103
buffer_store_dwordx2 v[94:95], v23, s[24:27], s22 offen nt
v_mfma_f32_16x16x32_bf16 v[36:39], a[236:239], a[124:127], v[36:39]
ds_read_b128 a[224:227], v16 offset:2048
v_mfma_f32_16x16x32_bf16 v[24:27], a[240:243], v[240:243], v[24:27]
v_mfma_f32_16x16x32_bf16 v[28:31], a[240:243], v[244:247], v[28:31]
v_mfma_f32_16x16x32_bf16 v[32:35], a[240:243], v[248:251], v[32:35]
v_mfma_f32_16x16x32_bf16 v[36:39], a[240:243], v[252:255], v[36:39]
ds_read_b128 a[228:231], v17 offset:2048
v_mfma_f32_16x16x32_bf16 v[40:43], a[244:247], a[128:131], v[24:27]
v_mfma_f32_16x16x32_bf16 v[44:47], a[244:247], a[132:135], v[28:31]
s_add_u32 m0, s56, 45056
v_mfma_f32_16x16x32_bf16 v[48:51], a[244:247], a[136:139], v[32:35]
buffer_load_dwordx4 v13, s[12:15], s50 offen  lds
v_mfma_f32_16x16x32_bf16 v[52:55], a[244:247], a[140:143], v[36:39]
ds_read_b128 a[232:235], v16 offset:4096
s_waitcnt lgkmcnt(4)
v_mfma_f32_16x16x32_bf16 v[24:27], a[248:251], v[112:115], 0
v_mfma_f32_16x16x32_bf16 v[28:31], a[248:251], v[116:119], 0
v_mfma_f32_16x16x32_bf16 v[32:35], a[248:251], v[120:123], 0
buffer_load_dwordx4 v13, s[12:15], s51 offen offset:2048  lds
v_mfma_f32_16x16x32_bf16 v[36:39], a[248:251], v[124:127], 0
ds_read_b128 a[236:239], v17 offset:4096
s_waitcnt lgkmcnt(4)
v_mfma_f32_16x16x32_bf16 v[24:27], a[252:255], a[0:3], v[24:27]
v_cvt_pk_bf16_f32 v88, v40, v44
v_cvt_pk_bf16_f32 v89, v48, v52
v_mfma_f32_16x16x32_bf16 v[28:31], a[252:255], a[4:7], v[28:31]
buffer_store_dwordx2 v[88:89], v20, s[24:27], s98 offen nt
v_mfma_f32_16x16x32_bf16 v[32:35], a[252:255], a[8:11], v[32:35]
v_mfma_f32_16x16x32_bf16 v[36:39], a[252:255], a[12:15], v[36:39]
ds_read_b128 a[240:243], v16 offset:6144
s_waitcnt lgkmcnt(4)
v_mfma_f32_16x16x32_bf16 v[24:27], a[224:227], v[128:131], v[24:27]
s_add_u32 m0, s56, 49152
v_mfma_f32_16x16x32_bf16 v[28:31], a[224:227], v[132:135], v[28:31]
buffer_load_dwordx4 v13, s[12:15], s52 offen  lds
v_mfma_f32_16x16x32_bf16 v[32:35], a[224:227], v[136:139], v[32:35]
v_mfma_f32_16x16x32_bf16 v[36:39], a[224:227], v[140:143], v[36:39]
ds_read_b128 a[244:247], v17 offset:6144
s_waitcnt lgkmcnt(4)
v_mfma_f32_16x16x32_bf16 v[24:27], a[228:231], a[16:19], v[24:27]
v_cvt_pk_bf16_f32 v90, v41, v45
v_cvt_pk_bf16_f32 v91, v49, v53
v_mfma_f32_16x16x32_bf16 v[28:31], a[228:231], a[20:23], v[28:31]
buffer_store_dwordx2 v[90:91], v21, s[24:27], s98 offen nt
v_mfma_f32_16x16x32_bf16 v[32:35], a[228:231], a[24:27], v[32:35]
v_mfma_f32_16x16x32_bf16 v[36:39], a[228:231], a[28:31], v[36:39]
ds_read_b128 a[248:251], v16 offset:8192
s_waitcnt lgkmcnt(4)
v_mfma_f32_16x16x32_bf16 v[24:27], a[232:235], v[144:147], v[24:27]
buffer_load_dwordx4 v13, s[12:15], s53 offen offset:2048  lds
v_mfma_f32_16x16x32_bf16 v[28:31], a[232:235], v[148:151], v[28:31]
v_mfma_f32_16x16x32_bf16 v[32:35], a[232:235], v[152:155], v[32:35]
v_mfma_f32_16x16x32_bf16 v[36:39], a[232:235], v[156:159], v[36:39]
ds_read_b128 a[252:255], v17 offset:8192
s_waitcnt lgkmcnt(4)
v_mfma_f32_16x16x32_bf16 v[24:27], a[236:239], a[32:35], v[24:27]
v_cvt_pk_bf16_f32 v92, v42, v46
v_cvt_pk_bf16_f32 v93, v50, v54
v_mfma_f32_16x16x32_bf16 v[28:31], a[236:239], a[36:39], v[28:31]
buffer_store_dwordx2 v[92:93], v22, s[24:27], s98 offen nt
v_mfma_f32_16x16x32_bf16 v[32:35], a[236:239], a[40:43], v[32:35]
v_mfma_f32_16x16x32_bf16 v[36:39], a[236:239], a[44:47], v[36:39]
ds_read_b128 a[224:227], v16 offset:10240
s_waitcnt lgkmcnt(4)
v_mfma_f32_16x16x32_bf16 v[24:27], a[240:243], v[160:163], v[24:27]
s_add_u32 m0, s56, 53248
v_mfma_f32_16x16x32_bf16 v[28:31], a[240:243], v[164:167], v[28:31]
buffer_load_dwordx4 v13, s[12:15], s54 offen  lds
v_mfma_f32_16x16x32_bf16 v[32:35], a[240:243], v[168:171], v[32:35]
v_mfma_f32_16x16x32_bf16 v[36:39], a[240:243], v[172:175], v[36:39]
ds_read_b128 a[228:231], v17 offset:10240
s_waitcnt lgkmcnt(4)
v_mfma_f32_16x16x32_bf16 v[24:27], a[244:247], a[48:51], v[24:27]
v_cvt_pk_bf16_f32 v94, v43, v47
v_cvt_pk_bf16_f32 v95, v51, v55
v_mfma_f32_16x16x32_bf16 v[28:31], a[244:247], a[52:55], v[28:31]
buffer_store_dwordx2 v[94:95], v23, s[24:27], s98 offen nt
v_mfma_f32_16x16x32_bf16 v[32:35], a[244:247], a[56:59], v[32:35]
v_mfma_f32_16x16x32_bf16 v[36:39], a[244:247], a[60:63], v[36:39]
ds_read_b128 a[232:235], v16 offset:12288
s_waitcnt lgkmcnt(4)
v_mfma_f32_16x16x32_bf16 v[24:27], a[248:251], v[176:179], v[24:27]
v_mfma_f32_16x16x32_bf16 v[28:31], a[248:251], v[180:183], v[28:31]
v_mfma_f32_16x16x32_bf16 v[32:35], a[248:251], v[184:187], v[32:35]
v_mfma_f32_16x16x32_bf16 v[36:39], a[248:251], v[188:191], v[36:39]
ds_read_b128 a[236:239], v17 offset:12288
s_waitcnt lgkmcnt(4)
v_mfma_f32_16x16x32_bf16 v[24:27], a[252:255], a[64:67], v[24:27]
s_add_u32 s22, s21, 442368
v_accvgpr_read_b32 v96, a192
v_mfma_f32_16x16x32_bf16 v[28:31], a[252:255], a[68:71], v[28:31]
v_accvgpr_read_b32 v97, a196
v_accvgpr_read_b32 v98, a200
v_mfma_f32_16x16x32_bf16 v[32:35], a[252:255], a[72:75], v[32:35]
v_accvgpr_read_b32 v99, a204
v_cvt_pk_bf16_f32 v88, v96, v97
v_mfma_f32_16x16x32_bf16 v[36:39], a[252:255], a[76:79], v[36:39]
ds_read_b128 a[240:243], v16 offset:14336
s_waitcnt lgkmcnt(4)
v_mfma_f32_16x16x32_bf16 v[24:27], a[224:227], v[192:195], v[24:27]
v_cvt_pk_bf16_f32 v89, v98, v99
buffer_store_dwordx2 v[88:89], v20, s[24:27], s22 offen nt
v_mfma_f32_16x16x32_bf16 v[28:31], a[224:227], v[196:199], v[28:31]
v_mfma_f32_16x16x32_bf16 v[32:35], a[224:227], v[200:203], v[32:35]
v_accvgpr_read_b32 v100, a193
v_accvgpr_read_b32 v101, a197
v_mfma_f32_16x16x32_bf16 v[36:39], a[224:227], v[204:207], v[36:39]
ds_read_b128 a[244:247], v17 offset:14336
s_waitcnt lgkmcnt(4)
v_mfma_f32_16x16x32_bf16 v[24:27], a[228:231], a[80:83], v[24:27]
v_accvgpr_read_b32 v102, a201
L_page_3:
s_cbranch_execz L_hopback
v_accvgpr_read_b32 v103, a205
v_mfma_f32_16x16x32_bf16 v[28:31], a[228:231], a[84:87], v[28:31]
v_cvt_pk_bf16_f32 v90, v100, v101
v_cvt_pk_bf16_f32 v91, v102, v103
v_mfma_f32_16x16x32_bf16 v[32:35], a[228:231], a[88:91], v[32:35]
buffer_store_dwordx2 v[90:91], v21, s[24:27], s22 offen nt
v_mfma_f32_16x16x32_bf16 v[36:39], a[228:231], a[92:95], v[36:39]
ds_read_b128 a[248:251], v16 offset:16384
s_waitcnt lgkmcnt(4)
v_mfma_f32_16x16x32_bf16 v[24:27], a[232:235], v[208:211], v[24:27]
v_mfma_f32_16x16x32_bf16 v[28:31], a[232:235], v[212:215], v[28:31]
v_mfma_f32_16x16x32_bf16 v[32:35], a[232:235], v[216:219], v[32:35]
v_accvgpr_read_b32 v96, a194
v_accvgpr_read_b32 v97, a198
v_mfma_f32_16x16x32_bf16 v[36:39], a[232:235], v[220:223], v[36:39]
ds_read_b128 a[252:255], v17 offset:16384
s_waitcnt lgkmcnt(4)
v_mfma_f32_16x16x32_bf16 v[24:27], a[236:239], a[96:99], v[24:27]
v_accvgpr_read_b32 v98, a202
v_accvgpr_read_b32 v99, a206
v_mfma_f32_16x16x32_bf16 v[28:31], a[236:239], a[100:103], v[28:31]
v_cvt_pk_bf16_f32 v92, v96, v97
v_cvt_pk_bf16_f32 v93, v98, v99
v_mfma_f32_16x16x32_bf16 v[32:35], a[236:239], a[104:107], v[32:35]
buffer_store_dwordx2 v[92:93], v22, s[24:27], s22 offen nt
v_mfma_f32_16x16x32_bf16 v[36:39], a[236:239], a[108:111], v[36:39]
s_waitcnt lgkmcnt(3)
v_mfma_f32_16x16x32_bf16 v[24:27], a[240:243], v[224:227], v[24:27]
v_mfma_f32_16x16x32_bf16 v[28:31], a[240:243], v[228:231], v[28:31]
v_mfma_f32_16x16x32_bf16 v[32:35], a[240:243], v[232:235], v[32:35]
v_accvgpr_read_b32 v100, a195
v_accvgpr_read_b32 v101, a199
v_mfma_f32_16x16x32_bf16 v[36:39], a[240:243], v[236:239], v[36:39]
s_waitcnt vmcnt(4) lgkmcnt(0)
s_barrier
ds_read_b128 a[224:227], v16 offset:36864
ds_read_b128 a[228:231], v17 offset:36864
v_mfma_f32_16x16x32_bf16 v[24:27], a[244:247], a[112:115], v[24:27]
v_accvgpr_read_b32 v102, a203
v_accvgpr_read_b32 v103, a207
v_mfma_f32_16x16x32_bf16 v[28:31], a[244:247], a[116:119], v[28:31]
v_cvt_pk_bf16_f32 v94, v100, v101
v_cvt_pk_bf16_f32 v95, v102, v103
v_mfma_f32_16x16x32_bf16 v[32:35], a[244:247], a[120:123], v[32:35]
s_cmp_eq_u32 s61, 0
s_cselect_b32 s23, s20, 0
s_cmp_eq_u32 s23, 0
s_cbranch_scc1 L_sk_x
v_add_u32 v13, s9, v13
s_add_u32 m0, s56, 73728
s_nop 0
buffer_load_dwordx4 v13, s[12:15], s46 offen  lds
buffer_load_dwordx4 v13, s[12:15], s47 offen offset:2048  lds
s_add_u32 m0, s56, 77824
s_nop 0
buffer_load_dwordx4 v13, s[12:15], s48 offen  lds
buffer_load_dwordx4 v13, s[12:15], s49 offen offset:2048  lds
s_add_u32 m0, s56, 81920
s_nop 0
buffer_load_dwordx4 v13, s[12:15], s50 offen  lds
buffer_load_dwordx4 v13, s[12:15], s51 offen offset:2048  lds
s_add_u32 m0, s56, 86016
s_nop 0
buffer_load_dwordx4 v13, s[12:15], s52 offen  lds
buffer_load_dwordx4 v13, s[12:15], s53 offen offset:2048  lds
s_add_u32 m0, s56, 90112
s_nop 0
buffer_load_dwordx4 v13, s[12:15], s54 offen  lds
L_sk_x:
buffer_store_dwordx2 v[94:95], v23, s[24:27], s22 offen nt
v_mfma_f32_16x16x32_bf16 v[36:39], a[244:247], a[124:127], v[36:39]
ds_read_b128 a[232:235], v16 offset:38912
v_mfma_f32_16x16x32_bf16 v[24:27], a[248:251], v[240:243], v[24:27]
v_mfma_f32_16x16x32_bf16 v[28:31], a[248:251], v[244:247], v[28:31]
v_mfma_f32_16x16x32_bf16 v[32:35], a[248:251], v[248:251], v[32:35]
v_mfma_f32_16x16x32_bf16 v[36:39], a[248:251], v[252:255], v[36:39]
ds_read_b128 a[236:239], v17 offset:38912
v_mfma_f32_16x16x32_bf16 v[40:43], a[252:255], a[128:131], v[24:27]
v_mfma_f32_16x16x32_bf16 v[44:47], a[252:255], a[132:135], v[28:31]
v_mfma_f32_16x16x32_bf16 v[48:51], a[252:255], a[136:139], v[32:35]
v_mfma_f32_16x16x32_bf16 v[52:55], a[252:255], a[140:143], v[36:39]
ds_read_b128 a[240:243], v16 offset:40960
s_waitcnt lgkmcnt(4)
v_mfma_f32_16x16x32_bf16 v[24:27], a[224:227], v[112:115], 0
v_mfma_f32_16x16x32_bf16 v[28:31], a[224:227], v[116:119], 0
v_mfma_f32_16x16x32_bf16 v[32:35], a[224:227], v[120:123], 0
v_mfma_f32_16x16x32_bf16 v[36:39], a[224:227], v[124:127], 0
ds_read_b128 a[244:247], v17 offset:40960
s_waitcnt lgkmcnt(4)
v_mfma_f32_16x16x32_bf16 v[24:27], a[228:231], a[0:3], v[24:27]
v_cvt_pk_bf16_f32 v88, v40, v44
v_cvt_pk_bf16_f32 v89, v48, v52
v_mfma_f32_16x16x32_bf16 v[28:31], a[228:231], a[4:7], v[28:31]
buffer_store_dwordx2 v[88:89], v20, s[24:27], s99 offen nt
v_mfma_f32_16x16x32_bf16 v[32:35], a[228:231], a[8:11], v[32:35]
v_mfma_f32_16x16x32_bf16 v[36:39], a[228:231], a[12:15], v[36:39]
ds_read_b128 a[248:251], v16 offset:43008
s_waitcnt lgkmcnt(4)
v_mfma_f32_16x16x32_bf16 v[24:27], a[232:235], v[128:131], v[24:27]
v_mfma_f32_16x16x32_bf16 v[28:31], a[232:235], v[132:135], v[28:31]
v_mfma_f32_16x16x32_bf16 v[32:35], a[232:235], v[136:139], v[32:35]
v_mfma_f32_16x16x32_bf16 v[36:39], a[232:235], v[140:143], v[36:39]
ds_read_b128 a[252:255], v17 offset:43008
s_waitcnt lgkmcnt(4)
v_mfma_f32_16x16x32_bf16 v[24:27], a[236:239], a[16:19], v[24:27]
v_mfma_f32_16x16x32_bf16 v[28:31], a[236:239], a[20:23], v[28:31]
v_mfma_f32_16x16x32_bf16 v[32:35], a[236:239], a[24:27], v[32:35]
v_mfma_f32_16x16x32_bf16 v[36:39], a[236:239], a[28:31], v[36:39]
ds_read_b128 a[224:227], v16 offset:45056
s_waitcnt lgkmcnt(4)
v_mfma_f32_16x16x32_bf16 v[24:27], a[240:243], v[144:147], v[24:27]
v_mfma_f32_16x16x32_bf16 v[28:31], a[240:243], v[148:151], v[28:31]
v_mfma_f32_16x16x32_bf16 v[32:35], a[240:243], v[152:155], v[32:35]
v_mfma_f32_16x16x32_bf16 v[36:39], a[240:243], v[156:159], v[36:39]
ds_read_b128 a[228:231], v17 offset:45056
s_waitcnt lgkmcnt(4)
v_mfma_f32_16x16x32_bf16 v[24:27], a[244:247], a[32:35], v[24:27]
v_cvt_pk_bf16_f32 v90, v41, v45
v_cvt_pk_bf16_f32 v91, v49, v53
v_mfma_f32_16x16x32_bf16 v[28:31], a[244:247], a[36:39], v[28:31]
buffer_store_dwordx2 v[90:91], v21, s[24:27], s99 offen nt
v_mfma_f32_16x16x32_bf16 v[32:35], a[244:247], a[40:43], v[32:35]
v_mfma_f32_16x16x32_bf16 v[36:39], a[244:247], a[44:47], v[36:39]
ds_read_b128 a[232:235], v16 offset:47104
s_waitcnt lgkmcnt(4)
v_mfma_f32_16x16x32_bf16 v[24:27], a[248:251], v[160:163], v[24:27]
v_mfma_f32_16x16x32_bf16 v[28:31], a[248:251], v[164:167], v[28:31]
v_mfma_f32_16x16x32_bf16 v[32:35], a[248:251], v[168:171], v[32:35]
v_mfma_f32_16x16x32_bf16 v[36:39], a[248:251], v[172:175], v[36:39]
ds_read_b128 a[236:239], v17 offset:47104
s_waitcnt lgkmcnt(4)
v_mfma_f32_16x16x32_bf16 v[24:27], a[252:255], a[48:51], v[24:27]
v_mfma_f32_16x16x32_bf16 v[28:31], a[252:255], a[52:55], v[28:31]
v_mfma_f32_16x16x32_bf16 v[32:35], a[252:255], a[56:59], v[32:35]
v_mfma_f32_16x16x32_bf16 v[36:39], a[252:255], a[60:63], v[36:39]
ds_read_b128 a[240:243], v16 offset:49152
s_waitcnt lgkmcnt(4)
v_mfma_f32_16x16x32_bf16 v[24:27], a[224:227], v[176:179], v[24:27]
v_mfma_f32_16x16x32_bf16 v[28:31], a[224:227], v[180:183], v[28:31]
v_mfma_f32_16x16x32_bf16 v[32:35], a[224:227], v[184:187], v[32:35]
v_mfma_f32_16x16x32_bf16 v[36:39], a[224:227], v[188:191], v[36:39]
ds_read_b128 a[244:247], v17 offset:49152
s_waitcnt lgkmcnt(4)
v_mfma_f32_16x16x32_bf16 v[24:27], a[228:231], a[64:67], v[24:27]
v_cvt_pk_bf16_f32 v92, v42, v46
v_cvt_pk_bf16_f32 v93, v50, v54
v_mfma_f32_16x16x32_bf16 v[28:31], a[228:231], a[68:71], v[28:31]
buffer_store_dwordx2 v[92:93], v22, s[24:27], s99 offen nt
v_mfma_f32_16x16x32_bf16 v[32:35], a[228:231], a[72:75], v[32:35]
v_mfma_f32_16x16x32_bf16 v[36:39], a[228:231], a[76:79], v[36:39]
ds_read_b128 a[248:251], v16 offset:51200
s_waitcnt lgkmcnt(4)
v_mfma_f32_16x16x32_bf16 v[24:27], a[232:235], v[192:195], v[24:27]
v_mfma_f32_16x16x32_bf16 v[28:31], a[232:235], v[196:199], v[28:31]
v_mfma_f32_16x16x32_bf16 v[32:35], a[232:235], v[200:203], v[32:35]
v_mfma_f32_16x16x32_bf16 v[36:39], a[232:235], v[204:207], v[36:39]
ds_read_b128 a[252:255], v17 offset:51200
s_waitcnt lgkmcnt(4)
v_mfma_f32_16x16x32_bf16 v[24:27], a[236:239], a[80:83], v[24:27]
v_mfma_f32_16x16x32_bf16 v[28:31], a[236:239], a[84:87], v[28:31]
v_mfma_f32_16x16x32_bf16 v[32:35], a[236:239], a[88:91], v[32:35]
v_mfma_f32_16x16x32_bf16 v[36:39], a[236:239], a[92:95], v[36:39]
ds_read_b128 a[224:227], v16 offset:53248
s_waitcnt lgkmcnt(4)
v_mfma_f32_16x16x32_bf16 v[24:27], a[240:243], v[208:211], v[24:27]
v_mfma_f32_16x16x32_bf16 v[28:31], a[240:243], v[212:215], v[28:31]
v_mfma_f32_16x16x32_bf16 v[32:35], a[240:243], v[216:219], v[32:35]
v_cvt_pk_bf16_f32 v94, v43, v47
v_cvt_pk_bf16_f32 v95, v51, v55
v_mfma_f32_16x16x32_bf16 v[36:39], a[240:243], v[220:223], v[36:39]
ds_read_b128 a[228:231], v17 offset:53248
s_waitcnt lgkmcnt(4)
v_mfma_f32_16x16x32_bf16 v[24:27], a[244:247], a[96:99], v[24:27]
buffer_store_dwordx2 v[94:95], v23, s[24:27], s99 offen nt
v_mfma_f32_16x16x32_bf16 v[28:31], a[244:247], a[100:103], v[28:31]
v_mfma_f32_16x16x32_bf16 v[32:35], a[244:247], a[104:107], v[32:35]
v_mfma_f32_16x16x32_bf16 v[36:39], a[244:247], a[108:111], v[36:39]
s_waitcnt lgkmcnt(3)
v_mfma_f32_16x16x32_bf16 v[24:27], a[248:251], v[224:227], v[24:27]
v_mfma_f32_16x16x32_bf16 v[28:31], a[248:251], v[228:231], v[28:31]
v_mfma_f32_16x16x32_bf16 v[32:35], a[248:251], v[232:235], v[32:35]
v_mfma_f32_16x16x32_bf16 v[36:39], a[248:251], v[236:239], v[36:39]
s_cmp_eq_u32 s20, 0
s_cbranch_scc1 L_nobar
s_waitcnt vmcnt(5)
s_barrier
L_nobar:
s_mul_i32 s23, s61, 18432
v_subrev_u32 v14, s23, v14
v_subrev_u32 v15, s23, v15
ds_read_b128 a[232:235], v14 offset:0
ds_read_b128 a[236:239], v15 offset:0
s_waitcnt lgkmcnt(4)
v_mfma_f32_16x16x32_bf16 v[24:27], a[252:255], a[112:115], v[24:27]
v_mfma_f32_16x16x32_bf16 v[28:31], a[252:255], a[116:119], v[28:31]
v_mfma_f32_16x16x32_bf16 v[32:35], a[252:255], a[120:123], v[32:35]
v_mfma_f32_16x16x32_bf16 v[36:39], a[252:255], a[124:127], v[36:39]
ds_read_b128 a[240:243], v14 offset:2048
s_waitcnt lgkmcnt(4)
v_mfma_f32_16x16x32_bf16 v[24:27], a[224:227], v[240:243], v[24:27]
v_mfma_f32_16x16x32_bf16 v[28:31], a[224:227], v[244:247], v[28:31]
v_mfma_f32_16x16x32_bf16 v[32:35], a[224:227], v[248:251], v[32:35]
v_mfma_f32_16x16x32_bf16 v[36:39], a[224:227], v[252:255], v[36:39]
ds_read_b128 a[244:247], v15 offset:2048
s_waitcnt lgkmcnt(4)
v_mfma_f32_16x16x32_bf16 v[40:43], a[228:231], a[128:131], v[24:27]
v_mfma_f32_16x16x32_bf16 v[44:47], a[228:231], a[132:135], v[28:31]
v_mfma_f32_16x16x32_bf16 v[48:51], a[228:231], a[136:139], v[32:35]
v_mfma_f32_16x16x32_bf16 v[52:55], a[228:231], a[140:143], v[36:39]
s_cmp_lg_u32 s20, 0
s_cbranch_scc1 L_extra
s_nop 7
v_cvt_pk_bf16_f32 v88, v40, v44
v_cvt_pk_bf16_f32 v89, v48, v52
buffer_store_dwordx2 v[88:89], v20, s[24:27], s100 offen nt
v_cvt_pk_bf16_f32 v90, v41, v45
v_cvt_pk_bf16_f32 v91, v49, v53
buffer_store_dwordx2 v[90:91], v21, s[24:27], s100 offen nt
v_cvt_pk_bf16_f32 v92, v42, v46
v_cvt_pk_bf16_f32 v93, v50, v54
buffer_store_dwordx2 v[92:93], v22, s[24:27], s100 offen nt
v_cvt_pk_bf16_f32 v94, v43, v47
v_cvt_pk_bf16_f32 v95, v51, v55
buffer_store_dwordx2 v[94:95], v23, s[24:27], s100 offen nt
s_branch L_fin
L_extra:
s_cmp_lg_u32 s61, 0
s_cbranch_scc1 L_extra1
ds_read_b128 a[248:251], v14 offset:4096
ds_read_b128 a[252:255], v15 offset:4096
ds_read_b128 a[224:227], v14 offset:6144
s_waitcnt lgkmcnt(6)
v_mfma_f32_16x16x32_bf16 v[24:27], a[232:235], v[112:115], 0
v_mfma_f32_16x16x32_bf16 v[28:31], a[232:235], v[116:119], 0
ds_read_b128 a[228:231], v15 offset:6144
s_waitcnt lgkmcnt(6)
v_mfma_f32_16x16x32_bf16 v[24:27], a[236:239], a[0:3], v[24:27]
v_mfma_f32_16x16x32_bf16 v[28:31], a[236:239], a[4:7], v[28:31]
ds_read_b128 a[232:235], v14 offset:8192
s_waitcnt lgkmcnt(6)
v_mfma_f32_16x16x32_bf16 v[24:27], a[240:243], v[128:131], v[24:27]
v_mfma_f32_16x16x32_bf16 v[28:31], a[240:243], v[132:135], v[28:31]
ds_read_b128 a[236:239], v15 offset:8192
s_waitcnt lgkmcnt(6)
v_mfma_f32_16x16x32_bf16 v[24:27], a[244:247], a[16:19], v[24:27]
v_cvt_pk_bf16_f32 v88, v40, v44
v_cvt_pk_bf16_f32 v89, v48, v52
v_mfma_f32_16x16x32_bf16 v[28:31], a[244:247], a[20:23], v[28:31]
ds_read_b128 a[240:243], v14 offset:10240
s_waitcnt lgkmcnt(6)
v_mfma_f32_16x16x32_bf16 v[24:27], a[248:251], v[144:147], v[24:27]
buffer_store_dwordx2 v[88:89], v20, s[24:27], s100 offen nt
v_mfma_f32_16x16x32_bf16 v[28:31], a[248:251], v[148:151], v[28:31]
ds_read_b128 a[244:247], v15 offset:10240
s_waitcnt lgkmcnt(6)
v_mfma_f32_16x16x32_bf16 v[24:27], a[252:255], a[32:35], v[24:27]
v_cvt_pk_bf16_f32 v90, v41, v45
v_cvt_pk_bf16_f32 v91, v49, v53
v_mfma_f32_16x16x32_bf16 v[28:31], a[252:255], a[36:39], v[28:31]
ds_read_b128 a[248:251], v14 offset:12288
s_waitcnt lgkmcnt(6)
v_mfma_f32_16x16x32_bf16 v[24:27], a[224:227], v[160:163], v[24:27]
buffer_store_dwordx2 v[90:91], v21, s[24:27], s100 offen nt
v_mfma_f32_16x16x32_bf16 v[28:31], a[224:227], v[164:167], v[28:31]
ds_read_b128 a[252:255], v15 offset:12288
s_waitcnt lgkmcnt(6)
v_mfma_f32_16x16x32_bf16 v[24:27], a[228:231], a[48:51], v[24:27]
v_cvt_pk_bf16_f32 v92, v42, v46
v_cvt_pk_bf16_f32 v93, v50, v54
v_mfma_f32_16x16x32_bf16 v[28:31], a[228:231], a[52:55], v[28:31]
ds_read_b128 a[224:227], v14 offset:14336
s_waitcnt lgkmcnt(6)
v_mfma_f32_16x16x32_bf16 v[24:27], a[232:235], v[176:179], v[24:27]
buffer_store_dwordx2 v[92:93], v22, s[24:27], s100 offen nt
v_mfma_f32_16x16x32_bf16 v[28:31], a[232:235], v[180:183], v[28:31]
ds_read_b128 a[228:231], v15 offset:14336
s_waitcnt lgkmcnt(6)
v_mfma_f32_16x16x32_bf16 v[24:27], a[236:239], a[64:67], v[24:27]
v_cvt_pk_bf16_f32 v94, v43, v47
v_cvt_pk_bf16_f32 v95, v51, v55
v_mfma_f32_16x16x32_bf16 v[28:31], a[236:239], a[68:71], v[28:31]
ds_read_b128 a[232:235], v14 offset:16384
s_waitcnt lgkmcnt(6)
v_mfma_f32_16x16x32_bf16 v[24:27], a[240:243], v[192:195], v[24:27]
buffer_store_dwordx2 v[94:95], v23, s[24:27], s100 offen nt
v_mfma_f32_16x16x32_bf16 v[28:31], a[240:243], v[196:199], v[28:31]
ds_read_b128 a[236:239], v15 offset:16384
s_waitcnt lgkmcnt(6)
v_mfma_f32_16x16x32_bf16 v[24:27], a[244:247], a[80:83], v[24:27]
v_mfma_f32_16x16x32_bf16 v[28:31], a[244:247], a[84:87], v[28:31]
s_waitcnt lgkmcnt(5)
v_mfma_f32_16x16x32_bf16 v[24:27], a[248:251], v[208:211], v[24:27]
v_mfma_f32_16x16x32_bf16 v[28:31], a[248:251], v[212:215], v[28:31]
s_waitcnt lgkmcnt(4)
v_mfma_f32_16x16x32_bf16 v[24:27], a[252:255], a[96:99], v[24:27]
v_mfma_f32_16x16x32_bf16 v[28:31], a[252:255], a[100:103], v[28:31]
s_waitcnt lgkmcnt(3)
v_mfma_f32_16x16x32_bf16 v[24:27], a[224:227], v[224:227], v[24:27]
v_mfma_f32_16x16x32_bf16 v[28:31], a[224:227], v[228:231], v[28:31]
s_waitcnt lgkmcnt(2)
v_mfma_f32_16x16x32_bf16 v[24:27], a[228:231], a[112:115], v[24:27]
v_mfma_f32_16x16x32_bf16 v[28:31], a[228:231], a[116:119], v[28:31]
s_waitcnt lgkmcnt(1)
v_mfma_f32_16x16x32_bf16 v[24:27], a[232:235], v[240:243], v[24:27]
v_mfma_f32_16x16x32_bf16 v[28:31], a[232:235], v[244:247], v[28:31]
s_waitcnt lgkmcnt(0)
v_mfma_f32_16x16x32_bf16 v[24:27], a[236:239], a[128:131], v[24:27]
v_mfma_f32_16x16x32_bf16 v[28:31], a[236:239], a[132:135], v[28:31]
s_nop 7
v_cvt_pk_bf16_f32 v96, v24, v28
v_cvt_pk_bf16_f32 v97, v25, v29
v_cvt_pk_bf16_f32 v98, v26, v30
v_cvt_pk_bf16_f32 v99, v27, v31
buffer_store_dword v96, v20, s[24:27], s101 offen offset:0
buffer_store_dword v97, v21, s[24:27], s101 offen offset:0
buffer_store_dword v98, v22, s[24:27], s101 offen offset:0
buffer_store_dword v99, v23, s[24:27], s101 offen offset:0
s_branch L_fin
L_extra1:
ds_read_b128 a[248:251], v14 offset:4096
ds_read_b128 a[252:255], v15 offset:4096
ds_read_b128 a[224:227], v14 offset:6144
s_waitcnt lgkmcnt(6)
v_mfma_f32_16x16x32_bf16 v[24:27], a[232:235], v[120:123], 0
v_mfma_f32_16x16x32_bf16 v[28:31], a[232:235], v[124:127], 0
ds_read_b128 a[228:231], v15 offset:6144
s_waitcnt lgkmcnt(6)
v_mfma_f32_16x16x32_bf16 v[24:27], a[236:239], a[8:11], v[24:27]
v_mfma_f32_16x16x32_bf16 v[28:31], a[236:239], a[12:15], v[28:31]
ds_read_b128 a[232:235], v14 offset:8192
s_waitcnt lgkmcnt(6)
v_mfma_f32_16x16x32_bf16 v[24:27], a[240:243], v[136:139], v[24:27]
v_mfma_f32_16x16x32_bf16 v[28:31], a[240:243], v[140:143], v[28:31]
ds_read_b128 a[236:239], v15 offset:8192
s_waitcnt lgkmcnt(6)
v_mfma_f32_16x16x32_bf16 v[24:27], a[244:247], a[24:27], v[24:27]
v_cvt_pk_bf16_f32 v88, v40, v44
v_cvt_pk_bf16_f32 v89, v48, v52
v_mfma_f32_16x16x32_bf16 v[28:31], a[244:247], a[28:31], v[28:31]
ds_read_b128 a[240:243], v14 offset:10240
s_waitcnt lgkmcnt(6)
v_mfma_f32_16x16x32_bf16 v[24:27], a[248:251], v[152:155], v[24:27]
buffer_store_dwordx2 v[88:89], v20, s[24:27], s100 offen nt
v_mfma_f32_16x16x32_bf16 v[28:31], a[248:251], v[156:159], v[28:31]
ds_read_b128 a[244:247], v15 offset:10240
s_waitcnt lgkmcnt(6)
v_mfma_f32_16x16x32_bf16 v[24:27], a[252:255], a[40:43], v[24:27]
v_cvt_pk_bf16_f32 v90, v41, v45
v_cvt_pk_bf16_f32 v91, v49, v53
v_mfma_f32_16x16x32_bf16 v[28:31], a[252:255], a[44:47], v[28:31]
ds_read_b128 a[248:251], v14 offset:12288
s_waitcnt lgkmcnt(6)
v_mfma_f32_16x16x32_bf16 v[24:27], a[224:227], v[168:171], v[24:27]
buffer_store_dwordx2 v[90:91], v21, s[24:27], s100 offen nt
v_mfma_f32_16x16x32_bf16 v[28:31], a[224:227], v[172:175], v[28:31]
ds_read_b128 a[252:255], v15 offset:12288
s_waitcnt lgkmcnt(6)
v_mfma_f32_16x16x32_bf16 v[24:27], a[228:231], a[56:59], v[24:27]
v_cvt_pk_bf16_f32 v92, v42, v46
v_cvt_pk_bf16_f32 v93, v50, v54
v_mfma_f32_16x16x32_bf16 v[28:31], a[228:231], a[60:63], v[28:31]
ds_read_b128 a[224:227], v14 offset:14336
s_waitcnt lgkmcnt(6)
v_mfma_f32_16x16x32_bf16 v[24:27], a[232:235], v[184:187], v[24:27]
buffer_store_dwordx2 v[92:93], v22, s[24:27], s100 offen nt
v_mfma_f32_16x16x32_bf16 v[28:31], a[232:235], v[188:191], v[28:31]
ds_read_b128 a[228:231], v15 offset:14336
s_waitcnt lgkmcnt(6)
v_mfma_f32_16x16x32_bf16 v[24:27], a[236:239], a[72:75], v[24:27]
v_cvt_pk_bf16_f32 v94, v43, v47
v_cvt_pk_bf16_f32 v95, v51, v55
v_mfma_f32_16x16x32_bf16 v[28:31], a[236:239], a[76:79], v[28:31]
ds_read_b128 a[232:235], v14 offset:16384
s_waitcnt lgkmcnt(6)
v_mfma_f32_16x16x32_bf16 v[24:27], a[240:243], v[200:203], v[24:27]
buffer_store_dwordx2 v[94:95], v23, s[24:27], s100 offen nt
v_mfma_f32_16x16x32_bf16 v[28:31], a[240:243], v[204:207], v[28:31]
ds_read_b128 a[236:239], v15 offset:16384
s_waitcnt lgkmcnt(6)
v_mfma_f32_16x16x32_bf16 v[24:27], a[244:247], a[88:91], v[24:27]
v_mfma_f32_16x16x32_bf16 v[28:31], a[244:247], a[92:95], v[28:31]
s_waitcnt lgkmcnt(5)
v_mfma_f32_16x16x32_bf16 v[24:27], a[248:251], v[216:219], v[24:27]
v_mfma_f32_16x16x32_bf16 v[28:31], a[248:251], v[220:223], v[28:31]
s_waitcnt lgkmcnt(4)
v_mfma_f32_16x16x32_bf16 v[24:27], a[252:255], a[104:107], v[24:27]
v_mfma_f32_16x16x32_bf16 v[28:31], a[252:255], a[108:111], v[28:31]
s_waitcnt lgkmcnt(3)
v_mfma_f32_16x16x32_bf16 v[24:27], a[224:227], v[232:235], v[24:27]
v_mfma_f32_16x16x32_bf16 v[28:31], a[224:227], v[236:239], v[28:31]
s_waitcnt lgkmcnt(2)
v_mfma_f32_16x16x32_bf16 v[24:27], a[228:231], a[120:123], v[24:27]
v_mfma_f32_16x16x32_bf16 v[28:31], a[228:231], a[124:127], v[28:31]
s_waitcnt lgkmcnt(1)
v_mfma_f32_16x16x32_bf16 v[24:27], a[232:235], v[248:251], v[24:27]
v_mfma_f32_16x16x32_bf16 v[28:31], a[232:235], v[252:255], v[28:31]
s_waitcnt lgkmcnt(0)
v_mfma_f32_16x16x32_bf16 v[24:27], a[236:239], a[136:139], v[24:27]
v_mfma_f32_16x16x32_bf16 v[28:31], a[236:239], a[140:143], v[28:31]
s_nop 7
v_cvt_pk_bf16_f32 v96, v24, v28
v_cvt_pk_bf16_f32 v97, v25, v29
v_cvt_pk_bf16_f32 v98, v26, v30
v_cvt_pk_bf16_f32 v99, v27, v31
buffer_store_dword v96, v20, s[24:27], s101 offen offset:4
buffer_store_dword v97, v21, s[24:27], s101 offen offset:4
buffer_store_dword v98, v22, s[24:27], s101 offen offset:4
buffer_store_dword v99, v23, s[24:27], s101 offen offset:4
L_fin:
L_end:
s_endpgm
.fill (L_main + 16384 - .) / 4, 4, 0xbf800000
.section .rodata,"a"
.p2align 6
.amdhsa_kernel standalone__weight_only_int_squeezellm__prompt_kernel
  .amdhsa_next_free_vgpr 512
  .amdhsa_next_free_sgpr 102
  .amdhsa_accum_offset 256
  .amdhsa_group_segment_fixed_size 0
  .amdhsa_kernarg_size 48
  .amdhsa_user_sgpr_count 2
  .amdhsa_user_sgpr_kernarg_segment_ptr 1
  .amdhsa_system_sgpr_workgroup_id_x 1
.end_amdhsa_kernel
```
